```python
import torch

def _softmax(x, axis=-1):
    return torch.softmax(x, dim=axis)
def _gelu(x):
    return torch.nn.functional.gelu(x, approximate="tanh")
def _silu(x):
    return torch.nn.functional.silu(x)
def _sigmoid(x):
    return torch.sigmoid(x)
def _layernorm(x, axis=-1, eps=1e-5):
    m = x.mean(dim=axis, keepdim=True)
    v = x.var(dim=axis, keepdim=True, unbiased=False)
    return (x - m) / torch.sqrt(v + eps)
def _scatter_add(tgt, idx, src, axis=0):
    return tgt.clone().index_add_(axis, idx, src)
def _segment_sum(src, seg, n):
    out = torch.zeros((n,) + src.shape[1:], dtype=src.dtype)
    return out.index_add_(0, seg, src)
def _pad(x, pw):
    flat = tuple(v for pair in reversed(pw) for v in pair)
    return torch.nn.functional.pad(x, flat)

kernel_name = 'gated_mix__ssm_conv_s5__linear_kernel_hedgehog__prompt'

def setup_inputs():

    _w = (lambda a: (lambda t: t.to(torch.bfloat16) if t.is_floating_point() else t)(torch.as_tensor(a)))
    def _A_setup():
        B, S, D = 1, 2048, 576
        P = D
        Lambda_re = -0.5 * (lambda _x: torch.exp(torch.as_tensor(_x)))((lambda *s: torch.randn(*s, dtype=torch.bfloat16) * 0.8)(P))
        Lambda_im = (lambda *s: torch.randn(*s, dtype=torch.bfloat16) * 0.8)(P) * 1.0
        B_re = (lambda *s: torch.randn(*s, dtype=torch.bfloat16) * 0.8)(P, D) * (D ** -0.5)
        B_im = (lambda *s: torch.randn(*s, dtype=torch.bfloat16) * 0.8)(P, D) * (D ** -0.5)
        C_re = (lambda *s: torch.randn(*s, dtype=torch.bfloat16) * 0.8)(D, P) * (P ** -0.5)
        C_im = (lambda *s: torch.randn(*s, dtype=torch.bfloat16) * 0.8)(D, P) * (P ** -0.5)
        log_dt = (lambda *s: torch.randn(*s, dtype=torch.bfloat16) * 0.8)(P) * 0.3 - 2.0
        Dskip = (lambda *s: torch.randn(*s, dtype=torch.bfloat16) * 0.8)(D)
        return {
            "x": _w((lambda *s: torch.randn(*s, dtype=torch.bfloat16) * 0.05)(B, S, D)),
            "Lambda_re": _w(Lambda_re),
            "Lambda_im": _w(Lambda_im),
            "B_re": _w(B_re),
            "B_im": _w(B_im),
            "C_re": _w(C_re),
            "C_im": _w(C_im),
            "log_dt": _w(log_dt),
            "Dskip": _w(Dskip),
        }
    _A_in = _A_setup()

    def _B_setup():
        B, S, D, H = 1, 2048, 576, 32
        Dh = D // H
        return {
            "x": _w((lambda *s: torch.randn(*s, dtype=torch.bfloat16) * 0.05)(B, S, D)),
            "wqkv": _w((lambda *s: torch.randn(*s, dtype=torch.bfloat16) * 1.6)(D, 3 * D)),
            "w_phi": _w((lambda *s: torch.randn(*s, dtype=torch.bfloat16) * 1.6)(H, Dh, Dh) * (Dh ** -0.5)),
            "wo": _w((lambda *s: torch.randn(*s, dtype=torch.bfloat16) * 0.05)(D, D)),
        }
    _B_in = _B_setup()

    return {
        "A_x": _A_in["x"],
        "A_Lambda_re": _A_in["Lambda_re"],
        "A_Lambda_im": _A_in["Lambda_im"],
        "A_B_re": _A_in["B_re"],
        "A_B_im": _A_in["B_im"],
        "A_C_re": _A_in["C_re"],
        "A_C_im": _A_in["C_im"],
        "A_log_dt": _A_in["log_dt"],
        "A_Dskip": _A_in["Dskip"],
        "B_x": _B_in["x"],
        "B_wqkv": _B_in["wqkv"],
        "B_w_phi": _B_in["w_phi"],
        "B_wo": _B_in["wo"],
        "gate_w": _w((lambda *s: torch.randn(*s, dtype=torch.bfloat16) * 0.05)(576) * 16.0),
    }

def reference(A_x, A_Lambda_re, A_Lambda_im, A_B_re, A_B_im, A_C_re, A_C_im, A_log_dt, A_Dskip, B_x, B_wqkv, B_w_phi, B_wo, gate_w):
    def _A_ref(x, Lambda_re, Lambda_im, B_re, B_im, C_re, C_im, log_dt, Dskip):
        Bsz, L, H = x.shape
        Lam = Lambda_re + 1j * Lambda_im
        Bmat = B_re + 1j * B_im
        Cmat = C_re + 1j * C_im
        dt = torch.exp(log_dt)
        Lam_bar = torch.exp(dt * Lam)
        B_bar = ((Lam_bar - 1.0) / Lam)[:, None] * Bmat
        Bu = torch.einsum("bld,pd->blp", x + 0j, B_bar)
        h = torch.zeros_like(Bu[:, 0, :])
        hs = []
        for t in range(L):
            h = Lam_bar[None, :] * h + Bu[:, t, :]
            hs.append(h)
        hseq = torch.stack(hs, 1)
        y = 2.0 * torch.einsum("blp,dp->bld", hseq, Cmat).real + x * Dskip[None, None, :]
        return y

    def _B_ref(x, wqkv, w_phi, wo):
        B, S, D = x.shape
        H = 32; Dh = D // H
        qkv = (lambda x, *d: x.permute(*d))((x @ wqkv).reshape(B, S, 3, H, Dh), 2, 0, 3, 1, 4)
        q, k, v = qkv[0], qkv[1], qkv[2]
        pq = torch.einsum("bhsd,hdf->bhsf", q, w_phi)
        pk = torch.einsum("bhsd,hdf->bhsf", k, w_phi)
        phi_q = torch.concatenate([_softmax(pq, axis=-1), _softmax(-pq, axis=-1)], axis=-1)
        phi_k = torch.concatenate([_softmax(pk, axis=-1), _softmax(-pk, axis=-1)], axis=-1)
        kv = torch.einsum("bhsf,bhsd->bhfd", phi_k, v)
        z  = torch.einsum("bhsf->bhf", phi_k)
        num = torch.einsum("bhqf,bhfd->bhqd", phi_q, kv)
        den = torch.einsum("bhqf,bhf->bhq", phi_q, z)[..., None] + 1e-6
        o = num / den
        return (lambda x, *d: x.permute(*d))(o, 0, 2, 1, 3).reshape(B, S, D) @ wo

    x = A_x
    g = _sigmoid((x * gate_w).sum(-1, keepdims=True))
    a = _A_ref(x, A_Lambda_re, A_Lambda_im, A_B_re, A_B_im, A_C_re, A_C_im, A_log_dt, A_Dskip)
    b = _B_ref(x, B_wqkv, B_w_phi, B_wo)
    return g * a + (1 - g) * b
```

```asm
; @launch grid=(256,1,1) block=(256,1,1) lds=163840
.amdgcn_target "amdgcn-amd-amdhsa--gfx950"
.text
.globl gated_mix__ssm_conv_s5__linear_kernel_hedgehog__prompt_kernel
.p2align 8
.type gated_mix__ssm_conv_s5__linear_kernel_hedgehog__prompt_kernel,@function
gated_mix__ssm_conv_s5__linear_kernel_hedgehog__prompt_kernel:
    s_cmp_ge_u32 s2, 256
    s_cbranch_scc1 L_end
    s_load_dwordx2 s[20:21], s[0:1], 80
    s_load_dwordx2 s[24:25], s[0:1], 88
    s_load_dwordx2 s[4:5], s[0:1], 0
    s_load_dwordx2 s[8:9], s[0:1], 24
    s_load_dwordx2 s[12:13], s[0:1], 32
    s_load_dwordx2 s[28:29], s[0:1], 128
    s_load_dwordx2 s[56:57], s[0:1], 104
    s_getpc_b64 s[58:59]
    s_and_b32 s63, s2, 0xf8
    v_lshrrev_b32 v1, 5, v0
    v_add_lshl_u32 v1, v1, s63, 7
    global_load_dword v2, v1, s[58:59]
    v_readfirstlane_b32 s61, v0
    v_and_b32 v9, 63, v0
    s_lshr_b32 s61, s61, 6
    s_and_b32 s63, s2, 1
    s_bfe_u32 s64, s2, 0x30003
    s_lshl3_add_u32 s3, s63, s64
    s_lshr_b32 s66, s2, 6
    s_bfe_u32 s63, s2, 0x20001
    s_lshl2_add_u32 s60, s63, s66
    s_lshl2_add_u32 s62, s3, s61
    s_mul_i32 s58, s62, 43
    s_lshr_b32 s58, s58, 7
    s_mul_i32 s64, s58, 3
    s_sub_u32 s59, s62, s64
    s_cmp_ge_u32 s62, 54
    s_cselect_b32 s67, 1073741824, 0
    s_cselect_b32 s58, 0, s58
    v_lshlrev_b32 v10, 4, v9
    v_mul_u32_u24 v3, 52, v9
    v_lshrrev_b32 v3, 8, v3
    v_mul_u32_u24 v4, 3376, v3
    v_add3_u32 v172, v4, v10, s67
    s_add_u32 s64, s59, 1
    s_cmp_eq_u32 s64, 3
    s_cselect_b32 s64, 0, s64
    s_mul_i32 s64, s64, 1152
    s_mul_i32 s65, s58, 110592
    s_add_u32 s64, s64, s65
    s_mul_i32 s65, s60, 72
    s_add_u32 s69, s64, s65
    s_lshl_b32 s68, s61, 13
    s_add_u32 s68, s68, 110592
    s_mov_b32 s22, 1990656
    s_mov_b32 s23, 0x20000
    s_mov_b32 m0, s68
    v_mov_b32 v11, 1073741824
    v_cmp_gt_u32 vcc, 40, v9
    s_cmp_eq_u32 s59, 1
    s_cselect_b32 s65, 1073741824, s67
    v_cndmask_b32_e64 v173, v11, v172, vcc
    v_or_b32 v174, s65, v10
    v_cmp_gt_u32 vcc, 17, v9
    s_mov_b32 s26, 20736
    s_mov_b32 s27, 0x20000
    v_cndmask_b32_e64 v175, v11, v174, vcc
    s_mul_i32 s70, s60, 1296
    v_lshrrev_b32 v3, 3, v9
    v_xor_b32 v162, v10, v9
    v_and_b32 v162, 0x70, v162
    v_mul_u32_u24 v6, 1152, v3
    v_add_u32 v162, v162, v6
    v_lshrrev_b32 v6, 5, v9
    v_mul_u32_u24 v6, 4608, v6
    s_mul_i32 s63, s62, 36864
    v_add3_u32 v164, v162, v6, s63
    v_xor_b32 v165, 64, v164
    v_add_u32 v166, 2560, v164
    v_add_u32 v167, 19968, v165
    v_add_u32 v165, 17408, v165
    s_lshr_b32 s63, s60, 2
    s_mul_i32 s63, s63, 2
    s_mul_i32 s65, s3, 1
    s_add_u32 s63, s63, s65
    s_mul_i32 s65, s63, 57
    s_lshr_b32 s65, s65, 9
    s_mul_i32 s65, s65, 9
    s_waitcnt lgkmcnt(0)
    s_sub_u32 s63, s63, s65
    s_lshl_b32 s73, s63, 7
    s_lshl_b32 s82, s61, 12
    s_lshl_b32 s83, s61, 11
    s_mov_b32 s6, 2359296
    s_mov_b32 s7, 0x20000
    s_mov_b32 s10, 663552
    s_mov_b32 s11, 0x20000
    s_mov_b32 s14, 664576
    s_mov_b32 s15, 0x20000
    s_mov_b32 s18, 663552
    s_mov_b32 s19, 0x20000
    s_mov_b32 s30, 268435456
    s_mov_b32 s31, 0x20000
    s_and_b32 s63, s60, 1
    s_mul_i32 s72, s60, 36
    s_lshl2_add_u32 s71, s63, s72
    s_xor_b32 s63, s63, 1
    s_lshl_b32 s63, s63, 5
    s_add_u32 s72, s72, s63
    s_lshl3_add_u32 s63, s61, s71
    s_mul_i32 s63, s63, 1152
    v_add_u32 v160, s63, v162
    v_xor_b32 v161, 64, v160
    s_bitcmp1_b32 s61, 0
    s_cselect_b64 s[16:17], s[12:13], s[8:9]
    s_sub_u32 s12, s12, 1024
    s_subb_u32 s13, s13, 0
    buffer_load_dwordx4 v172, s[20:23], s69 offen lds
    s_load_dword s84, s[28:29], 0
    s_load_dwordx2 s[32:33], s[0:1], 40
    s_load_dwordx2 s[36:37], s[0:1], 48
    s_load_dwordx2 s[40:41], s[0:1], 96
    s_load_dwordx2 s[44:45], s[0:1], 112
    s_load_dwordx4 s[48:51], s[0:1], 8
    s_load_dwordx4 s[52:55], s[0:1], 56
    v_lshrrev_b32 v13, 4, v9
    s_add_u32 s69, s69, 40512
    s_lshl_b32 s63, s58, 6
    buffer_load_dwordx4 v172, s[20:23], s69 offen offset:960 lds
    v_lshl_add_u32 v168, v13, 4, s63
    v_bfe_u32 v4, v9, 3, 2
    v_add_u32 v5, s72, v4
    v_mul_u32_u24 v5, 1152, v5
    s_and_b32 s63, s61, 1
    s_lshl_b32 s64, s63, 2
    v_and_or_b32 v4, v4, 2, s64
    v_xor_b32 v4, v4, v9
    v_and_b32 v4, 7, v4
    v_lshl_add_u32 v5, v4, 4, v5
    s_lshr_b32 s64, s61, 1
    s_lshl_b32 s65, s64, 8
    v_lshrrev_b32 v4, 5, v9
    v_lshl_add_u32 v4, v4, 7, s65
    s_add_u32 s69, s69, 40512
    s_mul_i32 s63, s63, 6144
    buffer_load_dwordx4 v173, s[20:23], s69 offen offset:1920 lds
    s_lshl_b32 s64, s64, 10
    s_add_u32 s85, s63, s64
    v_add_u32 v6, 0, v4
    v_cmp_gt_u32 vcc, 1152, v6
    v_add_u32 v6, s73, v6
    v_subrev_u32 v7, 1152, v6
    v_min_u32 v6, v6, v7
    v_add_u32 v6, v6, v5
    v_cndmask_b32_e64 v169, v11, v6, vcc
    v_add_u32 v6, 512, v4
    v_cmp_gt_u32 vcc, 1152, v6
    v_add_u32 v6, s73, v6
    v_subrev_u32 v7, 1152, v6
    v_min_u32 v6, v6, v7
    s_add_u32 m0, s68, 3072
    v_add_u32 v6, v6, v5
    buffer_load_dwordx4 v174, s[24:27], s70 offen lds
    v_cndmask_b32_e64 v170, v11, v6, vcc
    v_add_u32 v6, 1024, v4
    v_cmp_gt_u32 vcc, 1152, v6
    v_add_u32 v6, s73, v6
    v_subrev_u32 v7, 1152, v6
    v_min_u32 v6, v6, v7
    v_add_u32 v6, v6, v5
    v_cndmask_b32_e64 v171, v11, v6, vcc
    s_add_u32 s74, s73, 128
    s_cmp_eq_u32 s74, 1152
    s_cselect_b32 s74, 0, s74
    s_add_u32 s75, s74, 128
    s_cmp_eq_u32 s75, 1152
    s_cselect_b32 s75, 0, s75
    buffer_load_dwordx4 v175, s[24:27], s70 offen offset:1024 lds
    s_add_u32 s76, s75, 128
    s_cmp_eq_u32 s76, 1152
    s_cselect_b32 s76, 0, s76
    v_and_b32 v12, 15, v9
    v_and_b32 v61, 3, v12
    v_lshrrev_b32 v62, 2, v12
    v_lshl_add_u32 v60, v62, 3, v61
    v_lshrrev_b32 v7, 3, v12
    v_lshl_add_u32 v3, v7, 2, v61
    s_add_u32 s63, s68, 3072
    s_cmp_eq_u32 s59, 2
    s_cselect_b32 s64, 8, 0
    s_cselect_b32 s65, 0, 32
    s_add_u32 s64, s64, s63
    v_lshl_add_u32 v111, v3, 1, s64
    s_add_u32 m0, s82, 0
    s_lshl_b32 s64, s59, 2
    buffer_load_dwordx4 v164, s[4:7], s73 offen offset:0 lds
    s_sub_u32 s65, s65, s64
    s_add_u32 s65, s65, s63
    v_lshl_add_u32 v105, v3, 1, s65
    v_mul_u32_u24 v4, 288, v13
    v_add_u32 v110, v4, v111
    v_add_u32 v104, v4, v105
    v_mul_u32_u24 v108, 80, v60
    v_add_u32 v108, s68, v108
    v_lshl_add_u32 v109, v13, 4, v108
    v_mov_b64 v[28:29], 0
    v_mov_b64 v[30:31], 0
    v_mov_b64 v[32:33], 0
    v_mov_b64 v[34:35], 0
    v_mov_b64 v[50:51], 0
    buffer_load_dwordx4 v165, s[4:7], s73 offen offset:1024 lds
    v_mov_b64 v[54:55], 0
    v_mov_b64 v[58:59], 0
    v_cmp_le_u32 vcc, 18, v9
    v_mul_u32_u24 v106, 38, v9
    v_subrev_u32 v107, 36, v106
    v_cndmask_b32_e64 v106, v106, v107, vcc
    v_add_u32 v106, s63, v106
    v_mov_b32 v107, 0x3f80
    s_lshl_b32 s97, s60, 17
    s_add_u32 s97, s97, 2097152
    s_mul_i32 s99, s58, 5
    s_mul_i32 s63, s59, 3
    s_add_u32 s98, s99, s63
    s_lshl1_add_u32 s63, s58, 90
    s_cmp_eq_u32 s59, 2
    s_cselect_b32 s98, s63, s98
    buffer_load_dwordx4 v166, s[4:7], s73 offen offset:2048 lds
    s_lshl_b32 s98, s98, 10
    s_lshl_b32 s99, s99, 10
    s_add_u32 s63, s97, s67
    v_add_u32 v63, s63, v10
    v_lshrrev_b32 v4, 1, v3
    v_min_u32 v4, 2, v4
    v_and_b32 v8, 1, v12
    v_lshl_add_u32 v8, v62, 1, v8
    v_lshl_add_u32 v8, v13, 2, v8
    v_and_b32 v65, 7, v12
    v_lshl_add_u32 v65, v13, 3, v65
    v_cmp_gt_u32 vcc, 8, v12
    s_nop 1
    v_cndmask_b32_e64 v65, v65, v8, vcc
    v_lshlrev_b32 v65, 4, v65
    buffer_load_dwordx4 v167, s[4:7], s73 offen offset:3072 lds
    v_lshl_add_u32 v65, v4, 8, v65
    v_cmp_eq_u32 vcc, s59, v4
    v_add_u32 v64, s63, v65
    s_nop 0
    v_cndmask_b32_e64 v64, v11, v64, vcc
    v_lshrrev_b32 v4, 1, v12
    v_xor_b32 v4, v4, v13
    v_lshlrev_b32 v4, 4, v4
    v_lshl_add_u32 v4, v12, 7, v4
    v_add_u32 v153, s82, v4
    v_xor_b32 v154, 64, v153
    v_add_u32 v155, 65536, v4
    v_xor_b32 v148, 64, v155
    v_and_b32 v4, 6, v3
    v_xor_b32 v4, v4, v13
    v_lshlrev_b32 v4, 4, v4
    s_add_u32 m0, s83, 65536
    v_lshl_add_u32 v4, v61, 7, v4
    buffer_load_dwordx4 v160, s[8:11], s73 offen lds
    v_mul_u32_u24 v149, 6144, v7
    v_add_u32 v4, 98304, v4
    v_add_u32 v149, v149, v4
    v_xor_b32 v150, 64, v149
    s_waitcnt lgkmcnt(0)
    s_mul_i32 s84, s84, 0x9E3779B1
    s_add_u32 s84, s84, 0x7F4A7C15
    v_mov_b32 v14, s84
    s_add_u32 s77, s76, 128
    s_cmp_eq_u32 s77, 1152
    s_cselect_b32 s77, 0, s77
    s_add_u32 s78, s77, 128
    s_cmp_eq_u32 s78, 1152
    s_cselect_b32 s78, 0, s78
    s_add_u32 s79, s78, 128
    buffer_load_dwordx4 v161, s[12:15], s73 offen offset:1024 lds
    s_cmp_eq_u32 s79, 1152
    s_cselect_b32 s79, 0, s79
    s_add_u32 s80, s79, 128
    s_cmp_eq_u32 s80, 1152
    s_cselect_b32 s80, 0, s80
    s_add_u32 s81, s80, 128
    s_cmp_eq_u32 s81, 1152
    s_cselect_b32 s81, 0, s81
    s_lshl4_add_u32 s63, s3, s60
    s_lshl_b32 s63, s63, 9
    s_add_u32 s63, s63, 4096
    v_cmp_gt_u32 vcc, 32, v0
    v_lshl_add_u32 v66, v0, 2, s63
    s_nop 0
    v_cndmask_b32_e64 v66, v11, v66, vcc
    s_lshl_b32 s63, s60, 9
    s_add_u32 m0, s85, 98304
    s_add_u32 s63, s63, 4096
    buffer_load_dwordx4 v169, s[16:19], 0 offen lds
    v_lshrrev_b32 v4, 2, v9
    v_lshl_add_u32 v151, v4, 13, s63
    s_bfe_u32 s86, s2, 0x10001
    s_bfe_u32 s63, s2, 0x10002
    s_lshl2_add_u32 s87, s63, s66
    s_lshl1_add_u32 s88, s3, s86
    s_lshl2_add_u32 s88, s88, s61
    s_sub_u32 s65, s72, 32
    v_add_u32 v3, s71, v9
    v_add_u32 v4, s65, v9
    v_cmp_gt_u32 vcc, 32, v9
    s_nop 1
    v_cndmask_b32_e64 v3, v4, v3, vcc
    v_min_u32 v3, 575, v3
    v_lshlrev_b32 v3, 1, v3
    global_load_dwordx4 v[16:19], v168, s[56:57]
    global_load_ushort v163, v3, s[48:49]
    global_load_ushort v156, v3, s[50:51]
    global_load_ushort v157, v3, s[52:53]
    s_mul_i32 s89, s88, 57
    s_lshr_b32 s89, s89, 9
    s_mul_i32 s63, s89, 9
    s_sub_u32 s90, s88, s63
    s_cmp_ge_u32 s88, 81
    s_cselect_b32 s91, 1073741824, 0
    s_cselect_b32 s90, 0, s90
    s_cselect_b32 s89, 0, s89
    s_lshl_b32 s63, s90, 7
    s_add_u32 m0, s82, 16384
    v_lshl_add_u32 v3, v9, 1, s63
    buffer_load_dwordx4 v164, s[4:7], s74 offen offset:0 lds
    global_load_ushort v158, v3, s[48:49]
    global_load_ushort v159, v3, s[50:51]
    global_load_ushort v152, v3, s[52:53]
    s_mov_b32 s34, 663552
    s_mov_b32 s35, 0x20000
    s_mov_b32 s38, 663552
    s_mov_b32 s39, 0x20000
    s_mov_b32 s42, 663552
    s_mov_b32 s43, 0x20000
    s_mov_b32 s46, 4718592
    s_mov_b32 s47, 0x20000
    buffer_load_dwordx4 v165, s[4:7], s74 offen offset:1024 lds
    s_mul_i32 s64, s87, 9
    s_add_u32 s64, s64, s89
    s_mul_i32 s64, s64, 9216
    s_add_u32 s95, s64, s63
    v_or_b32 v162, s91, v162
    s_sub_u32 s63, 127, s88
    s_mul_i32 s92, s63, 205
    s_lshr_b32 s92, s92, 10
    s_mul_i32 s64, s92, 5
    s_sub_u32 s93, s63, s64
    s_cmp_ge_u32 s63, 90
    s_cselect_b32 s94, 1073741824, 0
    s_cselect_b32 s92, 0, s92
    v_lshrrev_b32 v5, 1, v9
    v_mul_u32_u24 v5, 1120, v5
    buffer_load_dwordx4 v166, s[4:7], s74 offen offset:2048 lds
    v_add3_u32 v15, v5, v10, s94
    s_mul_i32 s64, s92, 331776
    s_sub_u32 s64, s64, 5271552
    s_mul_i32 s65, s92, 41472
    s_cmp_ge_u32 s92, 16
    s_cselect_b32 s64, s64, s65
    s_cselect_b32 s65, 36864, 0
    v_lshrrev_b32 v5, 3, v9
    v_mad_u32_u24 v15, v5, s65, v15
    s_mul_i32 s65, s87, 144
    s_add_u32 s64, s64, s65
    s_lshl_b32 s65, s93, 5
    s_add_u32 s96, s64, s65
    s_waitcnt vmcnt(17)
    buffer_load_dwordx4 v167, s[4:7], s74 offen offset:3072 lds
    s_cmp_eq_u32 s59, 1
    s_cselect_b32 exec_lo, -1, 0
    s_cselect_b32 exec_hi, 15, 0
    ds_write_b16 v106, v107
    s_mov_b64 exec, 0xffff
    ds_read_b64 v[28:29], v108 offset:64
    ds_read_b64 v[32:33], v108 offset:384
    s_mov_b64 exec, -1
    ds_read_b128 v[20:23], v109 offset:0
    ds_read_b128 v[24:27], v109 offset:320
    s_add_u32 m0, s83, 73728
    ds_read_u16 v36, v110 offset:0
    buffer_load_dwordx4 v160, s[8:11], s74 offen lds
    ds_read_u16 v144, v110 offset:36
    ds_read_u16 v37, v110 offset:72
    ds_read_u16 v145, v110 offset:108
    ds_read_u16 v38, v110 offset:144
    ds_read_u16 v146, v110 offset:180
    ds_read_u16 v39, v110 offset:216
    ds_read_u16 v147, v110 offset:252
    buffer_load_dwordx4 v161, s[12:15], s74 offen offset:1024 lds
    ds_read_u16 v48, v111 offset:1152
    ds_read_u16 v140, v111 offset:1188
    ds_read_u16 v49, v111 offset:1224
    ds_read_u16 v141, v111 offset:1260
    ds_read_u16 v40, v110 offset:16
    ds_read_u16 v142, v110 offset:52
    ds_read_u16 v41, v110 offset:88
    ds_read_u16 v143, v110 offset:124
    s_add_u32 m0, s82, 32768
    ds_read_u16 v42, v110 offset:160
    buffer_load_dwordx4 v164, s[4:7], s75 offen offset:0 lds
    ds_read_u16 v136, v110 offset:196
    ds_read_u16 v43, v110 offset:232
    ds_read_u16 v137, v110 offset:268
    ds_read_u16 v52, v111 offset:1168
    ds_read_u16 v138, v111 offset:1204
    ds_read_u16 v53, v111 offset:1240
    ds_read_u16 v139, v111 offset:1276
    buffer_load_dwordx4 v165, s[4:7], s75 offen offset:1024 lds
    ds_read_u16 v44, v104 offset:0
    ds_read_u16 v132, v104 offset:36
    ds_read_u16 v45, v104 offset:72
    ds_read_u16 v133, v104 offset:108
    ds_read_u16 v46, v104 offset:144
    ds_read_u16 v134, v104 offset:180
    ds_read_u16 v47, v104 offset:216
    ds_read_u16 v135, v104 offset:252
    buffer_load_dwordx4 v166, s[4:7], s75 offen offset:2048 lds
    ds_read_u16 v56, v105 offset:1152
    ds_read_u16 v128, v105 offset:1188
    ds_read_u16 v57, v105 offset:1224
    ds_read_u16 v129, v105 offset:1260
    s_mov_b32 s24, 0xf0f0f0f0
    s_mov_b32 s25, 0xf0f0f0f0
    s_mov_b32 s20, 0x0f0f0f0f
    s_mov_b32 s21, 0xf0f00f0f
    s_mov_b32 s22, 0x0f0f0f0f
    s_mov_b32 s23, 0xf0f0f0f0
    s_cmp_eq_u32 s59, 2
    s_cselect_b32 s26, 0x44004400, 0
    buffer_load_dwordx4 v167, s[4:7], s75 offen offset:3072 lds
    s_mov_b32 s27, s26
    s_waitcnt lgkmcnt(15)
    v_lshl_or_b32 v49, v141, 16, v49
    v_lshl_or_b32 v48, v140, 16, v48
    v_lshl_or_b32 v39, v147, 16, v39
    v_lshl_or_b32 v38, v146, 16, v38
    v_lshl_or_b32 v37, v145, 16, v37
    v_lshl_or_b32 v36, v144, 16, v36
    v_cndmask_b32 v36, 0, v36, s[20:21]
    v_cndmask_b32 v37, 0, v37, s[22:23]
    v_cndmask_b32 v38, 0, v38, s[22:23]
    v_cndmask_b32 v39, 0, v39, s[22:23]
    v_cndmask_b32 v48, 0, v48, s[24:25]
    v_cndmask_b32 v49, 0, v49, s[24:25]
    s_waitcnt lgkmcnt(12)
    v_lshl_or_b32 v53, v139, 16, v53
    v_lshl_or_b32 v52, v138, 16, v52
    v_lshl_or_b32 v43, v137, 16, v43
    s_add_u32 m0, s83, 81920
    v_lshl_or_b32 v42, v136, 16, v42
    buffer_load_dwordx4 v160, s[8:11], s75 offen lds
    v_lshl_or_b32 v41, v143, 16, v41
    v_lshl_or_b32 v40, v142, 16, v40
    v_cndmask_b32 v40, 0, v40, s[20:21]
    v_cndmask_b32 v41, 0, v41, s[22:23]
    v_cndmask_b32 v42, 0, v42, s[22:23]
    v_cndmask_b32 v43, 0, v43, s[22:23]
    v_cndmask_b32 v52, 0, v52, s[24:25]
    v_cndmask_b32 v53, 0, v53, s[24:25]
    s_waitcnt lgkmcnt(0)
    v_lshl_or_b32 v57, v129, 16, v57
    v_lshl_or_b32 v56, v128, 16, v56
    v_lshl_or_b32 v47, v135, 16, v47
    v_lshl_or_b32 v46, v134, 16, v46
    v_lshl_or_b32 v45, v133, 16, v45
    v_lshl_or_b32 v44, v132, 16, v44
    v_cndmask_b32 v44, 0, v44, s[20:21]
    buffer_load_dwordx4 v161, s[12:15], s75 offen offset:1024 lds
    v_cndmask_b32 v45, 0, v45, s[22:23]
    v_cndmask_b32 v46, 0, v46, s[22:23]
    v_cndmask_b32 v47, 0, v47, s[22:23]
    v_cndmask_b32 v56, 0, v56, s[24:25]
    v_cndmask_b32 v57, 0, v57, s[24:25]
    v_mfma_f32_16x16x32_bf16 v[132:135], v[20:23], v[36:39], 0
    v_mfma_f32_16x16x32_bf16 v[128:131], v[24:27], v[36:39], 0
    v_mfma_f32_16x16x32_bf16 v[124:127], v[20:23], v[40:43], 0
    v_mfma_f32_16x16x32_bf16 v[120:123], v[24:27], v[40:43], 0
    s_add_u32 m0, s85, 100352
    v_mfma_f32_16x16x32_bf16 v[116:119], v[20:23], v[44:47], 0
    buffer_load_dwordx4 v170, s[16:19], 0 offen lds
    v_mfma_f32_16x16x32_bf16 v[112:115], v[24:27], v[44:47], 0
    v_mfma_f32_16x16x32_bf16 v[132:135], v[28:31], v[48:51], v[132:135]
    v_mfma_f32_16x16x32_bf16 v[128:131], v[32:35], v[48:51], v[128:131]
    s_add_u32 m0, s85, 102400
    v_mfma_f32_16x16x32_bf16 v[124:127], v[28:31], v[52:55], v[124:127]
    buffer_load_dwordx4 v171, s[16:19], 0 offen lds
    v_mfma_f32_16x16x32_bf16 v[120:123], v[32:35], v[52:55], v[120:123]
    v_mfma_f32_16x16x32_bf16 v[116:119], v[28:31], v[56:59], v[116:119]
    v_mfma_f32_16x16x32_bf16 v[112:115], v[32:35], v[56:59], v[112:115]
    s_nop 0
    v_cvt_pk_bf16_f32 v144, v132, v133
    v_cvt_pk_bf16_f32 v145, v134, v135
    v_cvt_pk_bf16_f32 v146, v128, v129
    s_add_u32 m0, s82, 49152
    v_cvt_pk_bf16_f32 v147, v130, v131
    buffer_load_dwordx4 v164, s[4:7], s76 offen offset:0 lds
    buffer_store_dwordx4 v[144:147], v63, s[28:31], s98 offen offset:0 sc1
    v_cvt_pk_bf16_f32 v140, v124, v125
    v_cvt_pk_bf16_f32 v141, v126, v127
    v_cvt_pk_bf16_f32 v142, v120, v121
    v_cvt_pk_bf16_f32 v143, v122, v123
    s_waitcnt vmcnt(22)
    v_cndmask_b32 v140, v140, v16, s[26:27]
    v_cndmask_b32 v141, v141, v17, s[26:27]
    v_cndmask_b32 v142, v142, v18, s[26:27]
    buffer_load_dwordx4 v165, s[4:7], s76 offen offset:1024 lds
    v_cndmask_b32 v143, v143, v19, s[26:27]
    buffer_store_dwordx4 v[140:143], v63, s[28:31], s98 offen offset:1024 sc1
    v_cvt_pk_bf16_f32 v136, v116, v117
    v_cvt_pk_bf16_f32 v137, v118, v119
    v_cvt_pk_bf16_f32 v138, v112, v113
    v_cvt_pk_bf16_f32 v139, v114, v115
    buffer_store_dwordx4 v[136:139], v64, s[28:31], s99 offen offset:2048 sc1
    s_barrier
    ds_read_b128 a[252:255], v153 offset:0
    ds_read_b128 v[212:215], v155 offset:0
    ds_read_b128 a[248:251], v153 offset:2048
    ds_read_b128 v[208:211], v155 offset:2048
    ds_read_b128 v[204:207], v155 offset:4096
    ds_read_b128 v[200:203], v155 offset:6144
    ds_read_b128 v[196:199], v149 offset:0
    s_waitcnt lgkmcnt(0)
    v_mfma_f32_16x16x32_bf16 v[252:255], a[252:255], v[212:215], 0
    ds_read_b128 a[244:247], v154 offset:0
    s_mul_i32 s16, s61, 1536
    s_add_u32 s16, s16, 154624
    s_mov_b32 s17, 0xffff0000
    v_mfma_f32_16x16x32_bf16 v[232:235], a[248:251], v[212:215], 0
    ds_read_b128 v[192:195], v148 offset:0
    buffer_load_dwordx4 v166, s[4:7], s76 offen offset:2048 lds
    s_mul_i32 s19, s61, 2560
    s_add_u32 s63, s19, s97
    v_mfma_f32_16x16x32_bf16 v[248:251], a[252:255], v[208:211], 0
    ds_read_b128 a[240:243], v154 offset:2048
    v_add_u32 v116, s63, v10
    s_lshl_b32 s22, s61, 10
    s_add_u32 s63, s22, s97
    s_add_u32 s63, s63, 92160
    v_mfma_f32_16x16x32_bf16 v[228:231], a[248:251], v[208:211], 0
    ds_read_b128 v[188:191], v148 offset:2048
    buffer_load_dwordx4 v167, s[4:7], s76 offen offset:3072 lds
    v_add_u32 v117, s63, v10
    v_add_u32 v118, 77824, v10
    v_mfma_f32_16x16x32_bf16 v[244:247], a[252:255], v[204:207], 0
    ds_read_b128 v[184:187], v148 offset:4096
    v_add_u32 v48, 77824, v65
    s_waitcnt vmcnt(26)
    v_lshlrev_b32 v163, 16, v163
    s_waitcnt vmcnt(25)
    v_lshlrev_b32 v156, 16, v156
    s_waitcnt vmcnt(24)
    v_lshlrev_b32 v157, 16, v157
    v_mfma_f32_16x16x32_bf16 v[224:227], a[248:251], v[204:207], 0
    ds_read_b128 v[180:183], v148 offset:6144
    s_add_u32 m0, s83, 90112
    v_mul_f32 v3, 1069066811, v157
    v_exp_f32 v3, v3
    v_mfma_f32_16x16x32_bf16 v[240:243], a[252:255], v[200:203], 0
    ds_read_b128 v[176:179], v150 offset:0
    v_cvt_pk_bf16_f32 v3, 0, v3
    v_mul_f32 v4, v3, v163
    v_mul_f32 v4, 1069066811, v4
    v_mul_f32 v5, v3, v156
    v_mfma_f32_16x16x32_bf16 v[220:223], a[248:251], v[200:203], 0
    buffer_load_dwordx4 v160, s[8:11], s76 offen lds
    v_mul_f32 v5, 0.15915494, v5
    v_rndne_f32 v8, v5
    v_sub_f32 v7, v5, v8
    v_mfma_f32_16x16x32_bf16 v[236:239], a[252:255], v[196:199], 0
    v_exp_f32 v6, v4
    v_cos_f32 v16, v7
    v_mfma_f32_16x16x32_bf16 v[216:219], a[248:251], v[196:199], 0
    buffer_load_dwordx4 v161, s[12:15], s76 offen offset:1024 lds
    s_waitcnt vmcnt(17) lgkmcnt(0)
    s_barrier
    v_sin_f32 v17, v7
    v_mfma_f32_16x16x32_bf16 v[252:255], a[244:247], v[192:195], v[252:255]
    ds_read_b128 a[236:239], v153 offset:16384
    s_add_u32 m0, s82, 0
    v_mul_f32 v16, v16, v6
    v_mul_f32 v17, v17, v6
    v_min_u32 v3, 39, v9
    v_mfma_f32_16x16x32_bf16 v[232:235], a[240:243], v[192:195], v[232:235]
    ds_read_b128 v[212:215], v155 offset:8192
    buffer_load_dwordx4 v164, s[4:7], s77 offen offset:0 lds
    v_lshl_add_u32 v44, v3, 3, s16
    v_mfma_f32_16x16x32_bf16 v[248:251], a[244:247], v[188:191], v[248:251]
    ds_read_b128 a[232:235], v153 offset:18432
    buffer_load_dwordx4 v165, s[4:7], s77 offen offset:1024 lds
    v_mfma_f32_16x16x32_bf16 v[228:231], a[240:243], v[188:191], v[228:231]
    ds_read_b128 v[208:211], v155 offset:10240
    buffer_load_dwordx4 v166, s[4:7], s77 offen offset:2048 lds
    v_mfma_f32_16x16x32_bf16 v[244:247], a[244:247], v[184:187], v[244:247]
    ds_read_b128 v[204:207], v155 offset:12288
    buffer_load_dwordx4 v167, s[4:7], s77 offen offset:3072 lds
    v_mfma_f32_16x16x32_bf16 v[224:227], a[240:243], v[184:187], v[224:227]
    ds_read_b128 v[200:203], v155 offset:14336
    s_add_u32 m0, s83, 65536
    ds_write_b64 v44, v[16:17]
    v_mfma_f32_16x16x32_bf16 v[240:243], a[244:247], v[180:183], v[240:243]
    ds_read_b128 v[196:199], v149 offset:512
    buffer_load_dwordx4 v160, s[8:11], s77 offen lds
    v_mul_u32_u24 v47, 56, v3
    v_add_u32 v47, 149504, v47
    v_mfma_f32_16x16x32_bf16 v[220:223], a[240:243], v[180:183], v[220:223]
    buffer_load_dwordx4 v161, s[12:15], s77 offen offset:1024 lds
    s_lshl_b32 s63, s61, 3
    v_add_u32 v46, s63, v47
    v_and_b32 v3, 7, v12
    v_lshl_add_u32 v3, v3, 3, s16
    v_mfma_f32_16x16x32_bf16 v[236:239], a[244:247], v[176:179], v[236:239]
    ds_read_b64 v[128:129], v3 offset:0
    ds_read_b64 v[130:131], v3 offset:64
    ds_read_b64 v[124:125], v3 offset:128
    v_mfma_f32_16x16x32_bf16 v[216:219], a[240:243], v[176:179], v[216:219]
    s_add_u32 m0, s68, 5120
    s_waitcnt lgkmcnt(3)
    ds_read_b64 v[126:127], v3 offset:192
    ds_read_b64 v[120:121], v3 offset:256
    v_mfma_f32_16x16x32_bf16 v[252:255], a[236:239], v[212:215], v[252:255]
    ds_read_b128 a[228:231], v154 offset:16384
    v_lshrrev_b32 v1, 3, v12
    v_lshl_add_u32 v45, v1, 2, v3
    v_mul_u32_u24 v3, 320, v13
    v_add_u32 v45, v45, v3
    v_mfma_f32_16x16x32_bf16 v[232:235], a[232:235], v[212:215], v[232:235]
    ds_read_b128 v[192:195], v148 offset:8192
    buffer_load_dwordx4 v162, s[32:35], s95 offen lds
    v_mov_b64 v[18:19], 0
    v_mfma_f32_16x16x32_bf16 v[248:251], a[236:239], v[208:211], v[248:251]
    ds_read_b128 a[224:227], v154 offset:18432
    ds_write_b64 v46, v[18:19]
    v_mul_f32 v6, 0x41000000, v4
    v_mfma_f32_16x16x32_bf16 v[228:231], a[232:235], v[208:211], v[228:231]
    ds_read_b128 v[188:191], v148 offset:10240
    s_add_u32 m0, s68, 6144
    v_mul_f32 v7, 0x41000000, v5
    v_rndne_f32 v8, v7
    v_sub_f32 v7, v7, v8
    v_mfma_f32_16x16x32_bf16 v[244:247], a[236:239], v[204:207], v[244:247]
    ds_read_b128 v[184:187], v148 offset:12288
    v_exp_f32 v6, v6
    v_cos_f32 v34, v7
    v_mfma_f32_16x16x32_bf16 v[224:227], a[232:235], v[204:207], v[224:227]
    ds_read_b128 v[180:183], v148 offset:14336
    buffer_load_dwordx4 v162, s[36:39], s95 offen lds
    v_sin_f32 v35, v7
    v_mfma_f32_16x16x32_bf16 v[240:243], a[236:239], v[200:203], v[240:243]
    ds_read_b128 v[176:179], v150 offset:512
    v_mul_f32 v34, v34, v6
    v_mul_f32 v35, v35, v6
    v_mul_f32 v6, 0x42000000, v4
    v_mul_f32 v7, 0x42000000, v5
    v_mfma_f32_16x16x32_bf16 v[220:223], a[232:235], v[200:203], v[220:223]
    s_add_u32 m0, s68, 7168
    v_rndne_f32 v8, v7
    v_sub_f32 v7, v7, v8
    v_exp_f32 v6, v6
    v_mfma_f32_16x16x32_bf16 v[236:239], a[236:239], v[196:199], v[236:239]
    v_cos_f32 v36, v7
    v_sin_f32 v37, v7
    v_mul_f32 v36, v36, v6
    v_mfma_f32_16x16x32_bf16 v[216:219], a[232:235], v[196:199], v[216:219]
    buffer_load_dwordx4 v15, s[40:43], s96 offen lds
    s_waitcnt vmcnt(13) lgkmcnt(0)
    s_barrier
    v_mul_f32 v37, v37, v6
    v_mul_f32 v6, 0x43000000, v4
    v_mfma_f32_16x16x32_bf16 v[252:255], a[228:231], v[192:195], v[252:255]
    ds_read_b128 a[220:223], v153 offset:32768
    buffer_store_dword v14, v66, s[28:31], 0 offen offset:0 sc1
    v_mul_f32 v7, 0x43000000, v5
    v_rndne_f32 v8, v7
    v_mfma_f32_16x16x32_bf16 v[232:235], a[224:227], v[192:195], v[232:235]
    ds_read_b128 v[212:215], v155 offset:16384
    s_add_u32 m0, s82, 16384
    v_sub_f32 v7, v7, v8
    v_exp_f32 v6, v6
    v_mfma_f32_16x16x32_bf16 v[248:251], a[228:231], v[188:191], v[248:251]
    ds_read_b128 a[216:219], v153 offset:34816
    buffer_load_dwordx4 v164, s[4:7], s78 offen offset:0 lds
    v_cos_f32 v38, v7
    v_mfma_f32_16x16x32_bf16 v[228:231], a[224:227], v[188:191], v[228:231]
    ds_read_b128 v[208:211], v155 offset:18432
    buffer_load_dwordx4 v165, s[4:7], s78 offen offset:1024 lds
    v_sin_f32 v39, v7
    v_mfma_f32_16x16x32_bf16 v[244:247], a[228:231], v[184:187], v[244:247]
    ds_read_b128 v[204:207], v155 offset:20480
    v_mul_f32 v38, v38, v6
    v_mul_f32 v39, v39, v6
    s_lshl_b32 s63, s61, 5
    v_cvt_f32_u32 v3, s63
    v_mfma_f32_16x16x32_bf16 v[224:227], a[224:227], v[184:187], v[224:227]
    ds_read_b128 v[200:203], v155 offset:22528
    buffer_load_dwordx4 v166, s[4:7], s78 offen offset:2048 lds
    v_mul_f32 v6, v3, v4
    v_mul_f32 v7, v3, v5
    v_mfma_f32_16x16x32_bf16 v[240:243], a[228:231], v[180:183], v[240:243]
    ds_read_b128 v[196:199], v149 offset:1024
    v_rndne_f32 v8, v7
    v_sub_f32 v7, v7, v8
    v_exp_f32 v6, v6
    v_mfma_f32_16x16x32_bf16 v[220:223], a[224:227], v[180:183], v[220:223]
    buffer_load_dwordx4 v167, s[4:7], s78 offen offset:3072 lds
    v_cos_f32 v40, v7
    v_sin_f32 v41, v7
    v_mfma_f32_16x16x32_bf16 v[236:239], a[228:231], v[176:179], v[236:239]
    v_mul_f32 v40, v40, v6
    v_mul_f32 v41, v41, v6
    s_sub_u32 s63, 3, s61
    s_lshl_b32 s63, s63, 9
    v_cvt_f32_u32 v3, s63
    v_mfma_f32_16x16x32_bf16 v[216:219], a[224:227], v[176:179], v[216:219]
    s_add_u32 m0, s83, 73728
    s_waitcnt lgkmcnt(0)
    v_mul_f32 v6, v3, v4
    v_mul_f32 v7, v3, v5
    v_rndne_f32 v8, v7
    v_sub_f32 v7, v7, v8
    v_mfma_f32_16x16x32_bf16 v[252:255], a[220:223], v[212:215], v[252:255]
    ds_read_b128 a[212:215], v154 offset:32768
    v_exp_f32 v6, v6
    v_cos_f32 v42, v7
    v_mfma_f32_16x16x32_bf16 v[232:235], a[216:219], v[212:215], v[232:235]
    ds_read_b128 v[192:195], v148 offset:16384
    buffer_load_dwordx4 v160, s[8:11], s78 offen lds
    v_sin_f32 v43, v7
    v_mfma_f32_16x16x32_bf16 v[248:251], a[220:223], v[208:211], v[248:251]
    ds_read_b128 a[208:211], v154 offset:34816
    v_mul_f32 v42, v42, v6
    v_mul_f32 v43, v43, v6
    v_xor_b32 v1, 1, v1
    v_lshlrev_b32 v1, 31, v1
    v_mfma_f32_16x16x32_bf16 v[228:231], a[216:219], v[208:211], v[228:231]
    ds_read_b128 v[188:191], v148 offset:18432
    buffer_load_dwordx4 v161, s[12:15], s78 offen offset:1024 lds
    v_xor_b32 v129, v1, v129
    v_xor_b32 v131, v1, v131
    v_mfma_f32_16x16x32_bf16 v[244:247], a[220:223], v[204:207], v[244:247]
    ds_read_b128 v[184:187], v148 offset:20480
    v_xor_b32 v125, v1, v125
    v_xor_b32 v127, v1, v127
    v_xor_b32 v121, v1, v121
    v_lshlrev_b32 v158, 16, v158
    v_mfma_f32_16x16x32_bf16 v[224:227], a[216:219], v[204:207], v[224:227]
    ds_read_b128 v[180:183], v148 offset:22528
    v_lshlrev_b32 v159, 16, v159
    v_lshlrev_b32 v152, 16, v152
    v_mul_f32 v3, 1069066811, v152
    v_mfma_f32_16x16x32_bf16 v[240:243], a[220:223], v[200:203], v[240:243]
    ds_read_b128 v[176:179], v150 offset:1024
    v_exp_f32 v3, v3
    s_nop 0
    v_cvt_pk_bf16_f32 v3, 0, v3
    v_mul_f32 v4, v3, v158
    v_mfma_f32_16x16x32_bf16 v[220:223], a[216:219], v[200:203], v[220:223]
    v_mul_f32 v4, 1069066811, v4
    v_mul_f32 v5, v3, v159
    v_mul_f32 v5, 0.15915494, v5
    v_rndne_f32 v8, v5
    v_sub_f32 v7, v5, v8
    v_mfma_f32_16x16x32_bf16 v[236:239], a[220:223], v[196:199], v[236:239]
    v_exp_f32 v6, v4
    v_cos_f32 v16, v7
    v_mfma_f32_16x16x32_bf16 v[216:219], a[216:219], v[196:199], v[216:219]
    s_waitcnt vmcnt(16) lgkmcnt(0)
    s_barrier
    v_sin_f32 v17, v7
    v_mul_f32 v16, v16, v6
    v_mul_f32 v17, v17, v6
    v_mfma_f32_16x16x32_bf16 v[252:255], a[212:215], v[192:195], v[252:255]
    ds_read_b128 a[204:207], v153 offset:49152
    s_add_u32 m0, s82, 32768
    v_add_f32 v6, -1.0, v16
    v_mul_f32 v7, v158, v158
    v_fmac_f32 v7, v159, v159
    v_mfma_f32_16x16x32_bf16 v[232:235], a[208:211], v[192:195], v[232:235]
    ds_read_b128 v[212:215], v155 offset:24576
    buffer_load_dwordx4 v164, s[4:7], s79 offen offset:0 lds
    v_rcp_f32 v7, v7
    v_mfma_f32_16x16x32_bf16 v[248:251], a[212:215], v[188:191], v[248:251]
    ds_read_b128 a[200:203], v153 offset:51200
    v_mul_f32 v18, v6, v158
    v_fmac_f32 v18, v17, v159
    v_mul_f32 v19, v17, v158
    v_fma_f32 v19, -v6, v159, v19
    v_mfma_f32_16x16x32_bf16 v[228:231], a[208:211], v[188:191], v[228:231]
    ds_read_b128 v[208:211], v155 offset:26624
    buffer_load_dwordx4 v165, s[4:7], s79 offen offset:1024 lds
    v_mul_f32 v18, v18, v7
    v_mul_f32 v19, v19, v7
    v_mfma_f32_16x16x32_bf16 v[244:247], a[212:215], v[184:187], v[244:247]
    ds_read_b128 v[204:207], v155 offset:28672
    v_lshl_add_u32 v3, v9, 3, s16
    ds_write_b64 v3, v[18:19]
    v_mfma_f32_16x16x32_bf16 v[224:227], a[208:211], v[184:187], v[224:227]
    ds_read_b128 v[200:203], v155 offset:30720
    buffer_load_dwordx4 v166, s[4:7], s79 offen offset:2048 lds
    v_lshrrev_b32 v4, 3, v9
    v_lshl_add_u32 v3, v4, 6, s16
    v_mfma_f32_16x16x32_bf16 v[240:243], a[212:215], v[180:183], v[240:243]
    ds_read_b128 v[196:199], v149 offset:1536
    ds_read_b128 v[172:175], v3 offset:0
    ds_read_b128 v[168:171], v3 offset:16
    v_mfma_f32_16x16x32_bf16 v[220:223], a[208:211], v[180:183], v[220:223]
    buffer_load_dwordx4 v167, s[4:7], s79 offen offset:3072 lds
    ds_read_b128 v[144:147], v3 offset:32
    ds_read_b128 v[140:143], v3 offset:48
    v_mfma_f32_16x16x32_bf16 v[236:239], a[212:215], v[176:179], v[236:239]
    v_and_b32 v5, 7, v9
    v_lshrrev_b32 v6, 1, v5
    v_xor_b32 v6, v6, v4
    v_lshlrev_b32 v6, 4, v6
    v_lshl_add_u32 v6, v5, 7, v6
    v_mfma_f32_16x16x32_bf16 v[216:219], a[208:211], v[176:179], v[216:219]
    s_add_u32 m0, s83, 81920
    s_waitcnt lgkmcnt(4)
    v_add_u32 v6, s68, v6
    s_waitcnt vmcnt(11)
    ds_read_b128 v[20:23], v6 offset:5120
    v_mfma_f32_16x16x32_bf16 v[252:255], a[204:207], v[212:215], v[252:255]
    ds_read_b128 a[196:199], v154 offset:49152
    ds_read_b128 v[24:27], v6 offset:6144
    v_lshl_add_u32 v7, v13, 3, v62
    v_lshlrev_b32 v7, 5, v7
    v_mfma_f32_16x16x32_bf16 v[232:235], a[200:203], v[212:215], v[232:235]
    ds_read_b128 v[192:195], v148 offset:24576
    buffer_load_dwordx4 v160, s[8:11], s79 offen lds
    v_lshl_add_u32 v7, v61, 3, v7
    v_add_u32 v7, s68, v7
    v_mfma_f32_16x16x32_bf16 v[248:251], a[204:207], v[208:211], v[248:251]
    ds_read_b128 a[192:195], v154 offset:51200
    ds_read_b64_tr_b16 v[28:29], v7 offset:7168
    ds_read_b64_tr_b16 v[30:31], v7 offset:7296
    v_mfma_f32_16x16x32_bf16 v[228:231], a[200:203], v[208:211], v[228:231]
    ds_read_b128 v[188:191], v148 offset:26624
    buffer_load_dwordx4 v161, s[12:15], s79 offen offset:1024 lds
    s_mul_i32 s18, s87, 248832
    s_add_u32 s18, s18, 12582912
    v_mfma_f32_16x16x32_bf16 v[244:247], a[204:207], v[204:207], v[244:247]
    ds_read_b128 v[184:187], v148 offset:28672
    s_lshl_b32 s64, s89, 9
    s_add_u32 s63, s64, s18
    s_add_u32 s63, s63, s91
    s_lshl_b32 s64, s90, 3
    v_mfma_f32_16x16x32_bf16 v[224:227], a[200:203], v[204:207], v[224:227]
    ds_read_b128 v[180:183], v148 offset:30720
    v_lshl_add_u32 v5, v5, 4, s63
    v_add_u32 v4, s64, v4
    v_mul_u32_u24 v6, 57, v4
    v_lshrrev_b32 v6, 9, v6
    v_mfma_f32_16x16x32_bf16 v[240:243], a[204:207], v[200:203], v[240:243]
    ds_read_b128 v[176:179], v150 offset:1536
    v_mul_u32_u24 v6, 9, v6
    v_add_u32 v3, v4, v6
    v_sub_u32 v4, v4, v6
    v_add_u32 v2, 4, v3
    v_mfma_f32_16x16x32_bf16 v[220:223], a[200:203], v[200:203], v[220:223]
    v_cmp_le_u32 vcc, 4, v4
    v_cmp_eq_u32 s[20:21], 4, v4
    s_nop 0
    v_cndmask_b32_e64 v3, v3, v2, vcc
    v_cndmask_b32 v2, 4, 9, s[20:21]
    v_add_u32 v2, v2, v3
    v_mfma_f32_16x16x32_bf16 v[236:239], a[204:207], v[196:199], v[236:239]
    v_lshrrev_b32 v6, 2, v3
    v_lshl_add_u32 v3, v3, 7, v5
    v_lshl_add_u32 v3, v6, 12, v3
    v_lshrrev_b32 v6, 2, v2
    v_lshl_add_u32 v2, v2, 7, v5
    v_mfma_f32_16x16x32_bf16 v[216:219], a[200:203], v[196:199], v[216:219]
    s_waitcnt lgkmcnt(0)
    s_barrier
    v_lshl_add_u32 v2, v6, 12, v2
    v_lshlrev_b32 v4, 16, v20
    v_lshlrev_b32 v5, 16, v24
    v_mul_f32 v16, v4, v172
    v_mfma_f32_16x16x32_bf16 v[252:255], a[196:199], v[192:195], v[252:255]
    ds_read_b128 a[188:191], v153 offset:0
    s_add_u32 m0, s82, 49152
    v_mul_f32 v18, v4, v173
    v_fma_f32 v16, -v5, v173, v16
    v_fmac_f32 v18, v5, v172
    v_mfma_f32_16x16x32_bf16 v[232:235], a[192:195], v[192:195], v[232:235]
    ds_read_b128 v[212:215], v155 offset:0
    buffer_load_dwordx4 v164, s[4:7], s80 offen offset:0 lds
    v_and_b32 v4, s17, v20
    v_and_b32 v5, s17, v24
    v_mfma_f32_16x16x32_bf16 v[248:251], a[196:199], v[188:191], v[248:251]
    ds_read_b128 a[184:187], v153 offset:2048
    v_mul_f32 v17, v4, v174
    v_mul_f32 v19, v4, v175
    v_fma_f32 v17, -v5, v175, v17
    v_fmac_f32 v19, v5, v174
    v_mfma_f32_16x16x32_bf16 v[228:231], a[192:195], v[188:191], v[228:231]
    ds_read_b128 v[208:211], v155 offset:2048
    buffer_load_dwordx4 v165, s[4:7], s80 offen offset:1024 lds
    v_cvt_pk_bf16_f32 v136, v16, v17
    v_cvt_pk_bf16_f32 v132, -v18, -v19
    v_mfma_f32_16x16x32_bf16 v[244:247], a[196:199], v[184:187], v[244:247]
    ds_read_b128 v[204:207], v155 offset:4096
    v_lshlrev_b32 v4, 16, v21
    v_lshlrev_b32 v5, 16, v25
    v_mul_f32 v16, v4, v168
    v_mul_f32 v18, v4, v169
    v_mfma_f32_16x16x32_bf16 v[224:227], a[192:195], v[184:187], v[224:227]
    ds_read_b128 v[200:203], v155 offset:6144
    buffer_load_dwordx4 v166, s[4:7], s80 offen offset:2048 lds
    v_fma_f32 v16, -v5, v169, v16
    v_fmac_f32 v18, v5, v168
    v_mfma_f32_16x16x32_bf16 v[240:243], a[196:199], v[180:183], v[240:243]
    ds_read_b128 v[196:199], v149 offset:2048
    v_and_b32 v4, s17, v21
    v_and_b32 v5, s17, v25
    v_mul_f32 v17, v4, v170
    v_mul_f32 v19, v4, v171
    v_mfma_f32_16x16x32_bf16 v[220:223], a[192:195], v[180:183], v[220:223]
    buffer_load_dwordx4 v167, s[4:7], s80 offen offset:3072 lds
    v_fma_f32 v17, -v5, v171, v17
    v_fmac_f32 v19, v5, v170
    v_cvt_pk_bf16_f32 v137, v16, v17
    v_cvt_pk_bf16_f32 v133, -v18, -v19
    v_mfma_f32_16x16x32_bf16 v[236:239], a[196:199], v[176:179], v[236:239]
    v_lshlrev_b32 v4, 16, v22
    v_lshlrev_b32 v5, 16, v26
    v_mul_f32 v16, v4, v144
    v_mul_f32 v18, v4, v145
    v_fma_f32 v16, -v5, v145, v16
    v_mfma_f32_16x16x32_bf16 v[216:219], a[192:195], v[176:179], v[216:219]
    s_add_u32 m0, s83, 90112
    s_waitcnt lgkmcnt(0)
    v_fmac_f32 v18, v5, v144
    v_and_b32 v4, s17, v22
    v_and_b32 v5, s17, v26
    v_mul_f32 v17, v4, v146
    v_mfma_f32_16x16x32_bf16 v[252:255], a[188:191], v[212:215], v[252:255]
    ds_read_b128 a[180:183], v154 offset:0
    v_mul_f32 v19, v4, v147
    v_fma_f32 v17, -v5, v147, v17
    v_fmac_f32 v19, v5, v146
    v_cvt_pk_bf16_f32 v138, v16, v17
    v_mfma_f32_16x16x32_bf16 v[232:235], a[184:187], v[212:215], v[232:235]
    ds_read_b128 v[192:195], v148 offset:0
    buffer_load_dwordx4 v160, s[8:11], s80 offen lds
    v_cvt_pk_bf16_f32 v134, -v18, -v19
    v_lshlrev_b32 v4, 16, v23
    v_mfma_f32_16x16x32_bf16 v[248:251], a[188:191], v[208:211], v[248:251]
    ds_read_b128 a[176:179], v154 offset:2048
    v_lshlrev_b32 v5, 16, v27
    v_mul_f32 v16, v4, v140
    v_mul_f32 v18, v4, v141
    v_fma_f32 v16, -v5, v141, v16
    v_mfma_f32_16x16x32_bf16 v[228:231], a[184:187], v[208:211], v[228:231]
    ds_read_b128 v[188:191], v148 offset:2048
    buffer_load_dwordx4 v161, s[12:15], s80 offen offset:1024 lds
    v_fmac_f32 v18, v5, v140
    v_and_b32 v4, s17, v23
    v_mfma_f32_16x16x32_bf16 v[244:247], a[188:191], v[204:207], v[244:247]
    ds_read_b128 v[184:187], v148 offset:4096
    v_and_b32 v5, s17, v27
    v_mul_f32 v17, v4, v142
    v_mul_f32 v19, v4, v143
    v_fma_f32 v17, -v5, v143, v17
    v_mfma_f32_16x16x32_bf16 v[224:227], a[184:187], v[204:207], v[224:227]
    ds_read_b128 v[180:183], v148 offset:6144
    v_fmac_f32 v19, v5, v142
    v_cvt_pk_bf16_f32 v139, v16, v17
    v_cvt_pk_bf16_f32 v135, -v18, -v19
    v_mov_b32 v4, v138
    v_mfma_f32_16x16x32_bf16 v[240:243], a[188:191], v[200:203], v[240:243]
    ds_read_b128 v[176:179], v150 offset:2048
    v_cndmask_b32 v138, v138, v132, s[20:21]
    v_cndmask_b32 v132, v132, v4, s[20:21]
    v_mov_b32 v4, v139
    v_cndmask_b32 v139, v139, v133, s[20:21]
    v_mfma_f32_16x16x32_bf16 v[220:223], a[184:187], v[200:203], v[220:223]
    v_cndmask_b32 v133, v133, v4, s[20:21]
    buffer_store_dwordx4 v[136:139], v3, s[28:31], 0 offen sc1
    buffer_store_dwordx4 v[132:135], v2, s[28:31], 0 offen sc1
    v_mfma_f32_16x16x32_bf16 v[236:239], a[188:191], v[196:199], v[236:239]
    v_and_b32 v4, 7, v12
    v_lshlrev_b32 v4, 4, v4
    v_lshl_add_u32 v4, v13, 7, v4
    v_lshrrev_b32 v5, 3, v12
    v_lshl_add_u32 v4, v5, 9, v4
    v_mfma_f32_16x16x32_bf16 v[216:219], a[184:187], v[196:199], v[216:219]
    s_waitcnt vmcnt(14) lgkmcnt(0)
    s_barrier
    v_add_u32 v32, s18, v4
    v_cmp_gt_u32 vcc, 8, v12
    v_add_u32 v33, 4096, v32
    s_nop 0
    v_cndmask_b32_e64 v33, v11, v33, vcc
    v_mfma_f32_16x16x32_bf16 v[252:255], a[180:183], v[192:195], v[252:255]
    ds_read_b128 a[172:175], v153 offset:16384
    buffer_load_dword v80, v151, s[28:31], 0 offen offset:0 sc1
    s_cmp_lg_u32 s93, 4
    s_cselect_b64 vcc, -1, vcc
    v_mfma_f32_16x16x32_bf16 v[232:235], a[176:179], v[192:195], v[232:235]
    ds_read_b128 v[212:215], v155 offset:8192
    s_add_u32 m0, s82, 0
    v_cndmask_b32_e64 v4, v11, v32, vcc
    v_or_b32 v4, s94, v4
    s_add_u32 s63, s92, 36
    v_mfma_f32_16x16x32_bf16 v[248:251], a[180:183], v[188:191], v[248:251]
    ds_read_b128 a[168:171], v153 offset:18432
    buffer_load_dwordx4 v164, s[4:7], s81 offen offset:0 lds
    s_mul_i32 s63, s63, 4608
    s_lshl_b32 s64, s93, 10
    v_mfma_f32_16x16x32_bf16 v[228:231], a[176:179], v[188:191], v[228:231]
    ds_read_b128 v[208:211], v155 offset:10240
    buffer_load_dwordx4 v165, s[4:7], s81 offen offset:1024 lds
    s_add_u32 s63, s63, s64
    v_mfma_f32_16x16x32_bf16 v[244:247], a[180:183], v[184:187], v[244:247]
    ds_read_b128 v[204:207], v155 offset:12288
    buffer_store_dwordx4 v[28:31], v4, s[28:31], s63 offen sc1
    s_movk_i32 s18, 4096
    s_movk_i32 s20, 8192
    v_mfma_f32_16x16x32_bf16 v[224:227], a[176:179], v[184:187], v[224:227]
    ds_read_b128 v[200:203], v155 offset:14336
    buffer_load_dwordx4 v166, s[4:7], s81 offen offset:2048 lds
    s_movk_i32 s21, 12288
    s_lshr_b32 s63, s87, 2
    v_mfma_f32_16x16x32_bf16 v[240:243], a[180:183], v[180:183], v[240:243]
    ds_read_b128 v[196:199], v149 offset:2560
    s_lshl3_add_u32 s63, s63, s66
    s_lshl_b32 s63, s63, 9
    s_add_u32 s63, s63, 4096
    v_bfe_u32 v3, v9, 1, 1
    v_mfma_f32_16x16x32_bf16 v[220:223], a[176:179], v[180:183], v[220:223]
    buffer_load_dwordx4 v167, s[4:7], s81 offen offset:3072 lds
    v_lshl_add_u32 v119, v3, 11, s63
    v_lshrrev_b32 v3, 2, v9
    v_lshl_add_u32 v119, v3, 13, v119
    s_lshl_b32 s63, s3, 13
    v_mfma_f32_16x16x32_bf16 v[236:239], a[180:183], v[176:179], v[236:239]
    s_add_u32 s63, s63, 4096
    v_lshl_add_u32 v49, v3, 9, s63
    s_lshl_b32 s63, s60, 14
    s_add_u32 s63, s63, 262144
    v_cmp_gt_u32 vcc, 40, v9
    v_add_u32 v50, s63, v10
    v_mfma_f32_16x16x32_bf16 v[216:219], a[176:179], v[176:179], v[216:219]
    s_add_u32 m0, s83, 65536
    s_waitcnt lgkmcnt(0)
    v_cndmask_b32_e64 v50, v11, v50, vcc
    s_lshl_b32 s63, s3, 10
    s_cmp_eq_u32 s61, 3
    s_cselect_b32 s63, s63, 1073741824
    v_mfma_f32_16x16x32_bf16 v[252:255], a[172:175], v[212:215], v[252:255]
    ds_read_b128 a[164:167], v154 offset:16384
    v_add_u32 v51, s63, v50
    s_cmp_eq_u32 s3, 15
    s_cselect_b32 s27, 0, -1
    s_lshl2_add_u32 s63, s61, s3
    v_mfma_f32_16x16x32_bf16 v[232:235], a[168:171], v[212:215], v[232:235]
    ds_read_b128 v[192:195], v148 offset:8192
    buffer_load_dwordx4 v160, s[8:11], s81 offen lds
    s_sub_u32 s23, s63, 16
    s_min_u32 s23, s23, 15
    v_mfma_f32_16x16x32_bf16 v[248:251], a[172:175], v[208:211], v[248:251]
    ds_read_b128 a[160:163], v154 offset:18432
    s_lshl_b32 s23, s23, 10
    s_sub_u32 s24, s63, 15
    s_min_u32 s24, s24, 15
    s_lshl_b32 s24, s24, 10
    v_mfma_f32_16x16x32_bf16 v[228:231], a[168:171], v[208:211], v[228:231]
    ds_read_b128 v[188:191], v148 offset:10240
    buffer_load_dwordx4 v161, s[12:15], s81 offen offset:1024 lds
    s_sub_u32 s25, s63, 14
    s_min_u32 s25, s25, 15
    v_mfma_f32_16x16x32_bf16 v[244:247], a[172:175], v[204:207], v[244:247]
    ds_read_b128 v[184:187], v148 offset:12288
    s_lshl_b32 s25, s25, 10
    s_sub_u32 s26, s63, 13
    s_min_u32 s26, s26, 15
    s_lshl_b32 s26, s26, 10
    v_mfma_f32_16x16x32_bf16 v[224:227], a[168:171], v[204:207], v[224:227]
    ds_read_b128 v[180:183], v148 offset:14336
    s_mul_i32 s32, s61, 41472
    v_and_b32 v3, 1, v13
    s_lshl_b32 s63, s61, 5
    v_add_u32 v4, s63, v12
    v_mfma_f32_16x16x32_bf16 v[240:243], a[172:175], v[200:203], v[240:243]
    ds_read_b128 v[176:179], v150 offset:2560
    v_lshrrev_b32 v5, 1, v13
    v_lshl_add_u32 v6, v5, 4, v4
    v_mul_u32_u24 v7, 112, v3
    v_add_u32 v7, 110592, v7
    v_mfma_f32_16x16x32_bf16 v[220:223], a[168:171], v[200:203], v[220:223]
    v_mul_u32_u24 v52, 224, v6
    v_add_u32 v52, v52, v7
    v_mul_u32_u24 v53, 224, v4
    v_lshl_add_u32 v7, v5, 3, v7
    v_add_u32 v53, v53, v7
    v_mfma_f32_16x16x32_bf16 v[236:239], a[172:175], v[196:199], v[236:239]
    s_mul_i32 s64, s61, 768
    s_add_u32 s64, s64, 110592
    v_mul_u32_u24 v56, 176, v6
    v_mul_u32_u24 v7, 80, v3
    v_add3_u32 v56, v56, v7, s64
    v_mul_u32_u24 v7, 176, v4
    v_mfma_f32_16x16x32_bf16 v[216:219], a[168:171], v[196:199], v[216:219]
    s_waitcnt vmcnt(16) lgkmcnt(0)
    s_barrier
    v_add_u32 v7, s64, v7
    v_lshl_add_u32 v57, v13, 4, v7
    v_lshl_add_u32 v58, v3, 4, v7
    s_lshl_b32 s63, s61, 7
    v_mfma_f32_16x16x32_bf16 v[252:255], a[164:167], v[192:195], v[252:255]
    ds_read_b128 a[156:159], v153 offset:32768
    s_waitcnt vmcnt(7)
    v_cmp_ne_u32 s[50:51], v80, v14
    s_nop 0
    s_cmp_lg_u64 s[50:51], 0
    s_cbranch_scc1 L_spin_f0
L_back_f0:
    s_add_u32 s63, s63, 154112
    v_mfma_f32_16x16x32_bf16 v[232:235], a[160:163], v[192:195], v[232:235]
    ds_read_b128 v[212:215], v155 offset:16384
    s_mul_i32 s69, s73, 80
    s_add_u32 m0, s19, 110592
    v_lshl_add_u32 v59, v60, 2, s63
    v_lshl_add_u32 v63, v5, 4, v59
    v_mfma_f32_16x16x32_bf16 v[248:251], a[164:167], v[188:191], v[248:251]
    ds_read_b128 a[152:155], v153 offset:34816
    buffer_load_dwordx4 v116, s[28:31], s69 offen sc1 lds
    v_lshrrev_b32 v4, 2, v9
    v_mul_u32_u24 v4, 224, v4
    v_mfma_f32_16x16x32_bf16 v[228:231], a[160:163], v[188:191], v[228:231]
    ds_read_b128 v[208:211], v155 offset:18432
    buffer_load_dwordx4 v116, s[28:31], s69 offen offset:1024 sc1 lds
    v_lshl_add_u32 v4, v61, 3, v4
    s_lshr_b32 s63, s61, 1
    v_mfma_f32_16x16x32_bf16 v[244:247], a[164:167], v[184:187], v[244:247]
    ds_read_b128 v[204:207], v155 offset:20480
    s_mov_b32 exec_hi, 0
    buffer_load_dwordx4 v116, s[28:31], s69 offen offset:2048 sc1 lds
    s_mov_b32 exec_hi, -1
    v_mfma_f32_16x16x32_bf16 v[224:227], a[160:163], v[184:187], v[224:227]
    ds_read_b128 v[200:203], v155 offset:22528
    s_mul_i32 s69, s74, 80
    s_add_u32 m0, s19, 120832
    s_mul_i32 s63, s63, 112
    s_add_u32 s63, s63, 110592
    v_mfma_f32_16x16x32_bf16 v[240:243], a[164:167], v[180:183], v[240:243]
    ds_read_b128 v[196:199], v149 offset:3072
    buffer_load_dwordx4 v116, s[28:31], s69 offen sc1 lds
    s_and_b32 s33, s61, 1
    s_lshl_b32 s64, s33, 5
    v_mfma_f32_16x16x32_bf16 v[220:223], a[160:163], v[180:183], v[220:223]
    buffer_load_dwordx4 v116, s[28:31], s69 offen offset:1024 sc1 lds
    s_add_u32 s64, s64, s63
    v_add_u32 v54, s63, v4
    v_add_u32 v55, s64, v4
    v_mfma_f32_16x16x32_bf16 v[236:239], a[164:167], v[176:179], v[236:239]
    s_mov_b32 exec_hi, 0
    buffer_load_dwordx4 v116, s[28:31], s69 offen offset:2048 sc1 lds
    s_mov_b32 exec_hi, -1
    v_mfma_f32_16x16x32_bf16 v[216:219], a[160:163], v[176:179], v[216:219]
    s_mul_i32 s69, s75, 80
    s_add_u32 m0, s19, 131072
    s_waitcnt lgkmcnt(0)
    v_mfma_f32_16x16x32_bf16 v[252:255], a[156:159], v[212:215], v[252:255]
    ds_read_b128 a[148:151], v154 offset:32768
    buffer_load_dwordx4 v116, s[28:31], s69 offen sc1 lds
    v_mfma_f32_16x16x32_bf16 v[232:235], a[152:155], v[212:215], v[232:235]
    ds_read_b128 v[192:195], v148 offset:16384
    buffer_load_dwordx4 v116, s[28:31], s69 offen offset:1024 sc1 lds
    v_mfma_f32_16x16x32_bf16 v[248:251], a[156:159], v[208:211], v[248:251]
    ds_read_b128 a[144:147], v154 offset:34816
    v_mfma_f32_16x16x32_bf16 v[228:231], a[152:155], v[208:211], v[228:231]
    ds_read_b128 v[188:191], v148 offset:18432
    s_mov_b32 exec_hi, 0
    buffer_load_dwordx4 v116, s[28:31], s69 offen offset:2048 sc1 lds
    s_mov_b32 exec_hi, -1
    v_mfma_f32_16x16x32_bf16 v[244:247], a[156:159], v[204:207], v[244:247]
    ds_read_b128 v[184:187], v148 offset:20480
    v_mfma_f32_16x16x32_bf16 v[224:227], a[152:155], v[204:207], v[224:227]
    ds_read_b128 v[180:183], v148 offset:22528
    s_mul_i32 s69, s76, 80
    s_add_u32 m0, s19, 16384
    v_mfma_f32_16x16x32_bf16 v[240:243], a[156:159], v[200:203], v[240:243]
    ds_read_b128 v[176:179], v150 offset:3072
    v_mfma_f32_16x16x32_bf16 v[220:223], a[152:155], v[200:203], v[220:223]
    buffer_load_dwordx4 v116, s[28:31], s69 offen sc1 lds
    v_mfma_f32_16x16x32_bf16 v[236:239], a[156:159], v[196:199], v[236:239]
    s_cmp_eq_u32 s33, 0
    s_cselect_b32 vcc_lo, -1, 0x000f000f
    s_cselect_b32 vcc_hi, 0xffff, vcc_lo
    s_cselect_b32 s63, 16, 4
    s_cselect_b32 s64, 0, 96
    s_cselect_b32 s34, 48, 16
    v_mfma_f32_16x16x32_bf16 v[216:219], a[152:155], v[196:199], v[216:219]
    buffer_load_dwordx4 v116, s[28:31], s69 offen offset:1024 sc1 lds
    s_waitcnt lgkmcnt(0)
    s_barrier
    v_mad_u32_u24 v4, v13, s63, v12
    v_add_u32 v4, s64, v4
    v_mfma_f32_16x16x32_bf16 v[252:255], a[148:151], v[192:195], v[252:255]
    ds_read_b128 a[140:143], v153 offset:49152
    s_mov_b32 exec_hi, 0
    buffer_load_dwordx4 v116, s[28:31], s69 offen offset:2048 sc1 lds
    s_mov_b32 exec_hi, -1
    v_mfma_f32_16x16x32_bf16 v[232:235], a[144:147], v[192:195], v[232:235]
    ds_read_b128 v[212:215], v155 offset:24576
    s_mul_i32 s69, s77, 80
    s_add_u32 m0, s19, 26624
    v_mfma_f32_16x16x32_bf16 v[248:251], a[148:151], v[188:191], v[248:251]
    ds_read_b128 a[136:139], v153 offset:51200
    buffer_load_dwordx4 v116, s[28:31], s69 offen sc1 lds
    v_mfma_f32_16x16x32_bf16 v[228:231], a[144:147], v[188:191], v[228:231]
    ds_read_b128 v[208:211], v155 offset:26624
    buffer_load_dwordx4 v116, s[28:31], s69 offen offset:1024 sc1 lds
    v_mfma_f32_16x16x32_bf16 v[244:247], a[148:151], v[184:187], v[244:247]
    ds_read_b128 v[204:207], v155 offset:28672
    s_lshl_b32 s65, s60, 16
    v_mfma_f32_16x16x32_bf16 v[224:227], a[144:147], v[184:187], v[224:227]
    ds_read_b128 v[200:203], v155 offset:30720
    s_mov_b32 exec_hi, 0
    buffer_load_dwordx4 v116, s[28:31], s69 offen offset:2048 sc1 lds
    s_mov_b32 exec_hi, -1
    v_mfma_f32_16x16x32_bf16 v[240:243], a[148:151], v[180:183], v[240:243]
    ds_read_b128 v[196:199], v149 offset:3584
    s_add_u32 s65, s65, 524288
    v_mfma_f32_16x16x32_bf16 v[220:223], a[144:147], v[180:183], v[220:223]
    s_mul_i32 s69, s78, 80
    s_add_u32 m0, s19, 36864
    s_lshl_b32 s64, s3, 10
    s_add_u32 s64, s64, s65
    v_mfma_f32_16x16x32_bf16 v[236:239], a[148:151], v[176:179], v[236:239]
    s_lshr_b32 s63, s61, 1
    s_lshl_b32 s63, s63, 15
    s_add_u32 s64, s64, s63
    v_lshrrev_b32 v7, 6, v4
    v_mfma_f32_16x16x32_bf16 v[216:219], a[144:147], v[176:179], v[216:219]
    buffer_load_dwordx4 v116, s[28:31], s69 offen sc1 lds
    s_waitcnt lgkmcnt(0)
    v_and_b32 v6, 63, v4
    v_mfma_f32_16x16x32_bf16 v[252:255], a[140:143], v[212:215], v[252:255]
    ds_read_b128 a[132:135], v154 offset:49152
    v_lshl_add_u32 v6, v6, 4, s64
    v_lshl_add_u32 v6, v7, 14, v6
    v_mfma_f32_16x16x32_bf16 v[232:235], a[136:139], v[212:215], v[232:235]
    ds_read_b128 v[192:195], v148 offset:24576
    buffer_load_dwordx4 v116, s[28:31], s69 offen offset:1024 sc1 lds
    v_mfma_f32_16x16x32_bf16 v[248:251], a[140:143], v[208:211], v[248:251]
    ds_read_b128 a[128:131], v154 offset:51200
    v_cndmask_b32_e64 v64, v11, v6, vcc
    v_add_u32 v4, s34, v4
    v_mfma_f32_16x16x32_bf16 v[228:231], a[136:139], v[208:211], v[228:231]
    ds_read_b128 v[188:191], v148 offset:26624
    s_mov_b32 exec_hi, 0
    buffer_load_dwordx4 v116, s[28:31], s69 offen offset:2048 sc1 lds
    s_mov_b32 exec_hi, -1
    v_mfma_f32_16x16x32_bf16 v[244:247], a[140:143], v[204:207], v[244:247]
    ds_read_b128 v[184:187], v148 offset:28672
    v_lshrrev_b32 v7, 6, v4
    v_mfma_f32_16x16x32_bf16 v[224:227], a[136:139], v[204:207], v[224:227]
    ds_read_b128 v[180:183], v148 offset:30720
    v_and_b32 v6, 63, v4
    v_lshl_add_u32 v6, v6, 4, s64
    v_mfma_f32_16x16x32_bf16 v[240:243], a[140:143], v[200:203], v[240:243]
    ds_read_b128 v[176:179], v150 offset:3584
    v_lshl_add_u32 v6, v7, 14, v6
    v_cndmask_b32_e64 v67, v11, v6, vcc
    v_mfma_f32_16x16x32_bf16 v[220:223], a[136:139], v[200:203], v[220:223]
    s_lshl_b32 s63, s61, 14
    s_add_u32 s63, s63, s65
    v_add_u32 v68, s63, v10
    s_mov_b32 s34, -1
    v_mfma_f32_16x16x32_bf16 v[236:239], a[140:143], v[196:199], v[236:239]
    s_cmp_eq_u32 s33, 0
    s_cselect_b32 s35, -1, 0x07770777
    v_bfe_u32 v4, v0, 4, 3
    v_cmp_le_u32 vcc, 3, v4
    v_mfma_f32_16x16x32_bf16 v[216:219], a[136:139], v[196:199], v[216:219]
    s_waitcnt vmcnt(18) lgkmcnt(0)
    s_barrier
    v_mul_u32_u24 v6, 24, v4
    v_subrev_u32 v7, 60, v6
    v_mfma_f32_16x16x32_bf16 v[252:255], a[132:135], v[192:195], v[252:255]
    ds_read_b128 a[124:127], v153 offset:0
    v_cndmask_b32_e64 v6, v6, v7, vcc
    s_movk_i32 s64, 208
    v_mfma_f32_16x16x32_bf16 v[232:235], a[128:131], v[192:195], v[232:235]
    ds_read_b128 v[212:215], v155 offset:0
    buffer_store_dword v14, v66, s[28:31], 0 offen offset:128 sc1
    v_mfma_f32_16x16x32_bf16 v[248:251], a[132:135], v[188:191], v[248:251]
    ds_read_b128 a[120:123], v153 offset:2048
    v_mad_u32_u24 v6, v12, s64, v6
    v_mul_u32_u24 v7, 12, v3
    v_mfma_f32_16x16x32_bf16 v[228:231], a[128:131], v[188:191], v[228:231]
    ds_read_b128 v[208:211], v155 offset:2048
    s_mul_i32 s69, s79, 80
    s_add_u32 m0, s19, 47104
    v_mfma_f32_16x16x32_bf16 v[244:247], a[132:135], v[184:187], v[244:247]
    ds_read_b128 v[204:207], v155 offset:4096
    v_mad_u32_u24 v7, v62, 24, v7
    v_mad_u32_u24 v7, v61, s64, v7
    v_mfma_f32_16x16x32_bf16 v[224:227], a[128:131], v[184:187], v[224:227]
    ds_read_b128 v[200:203], v155 offset:6144
    buffer_load_dwordx4 v116, s[28:31], s69 offen sc1 lds
    v_mfma_f32_16x16x32_bf16 v[240:243], a[132:135], v[180:183], v[240:243]
    ds_read_b128 v[196:199], v149 offset:4096
    v_add_u32 v7, 3328, v7
    v_cmp_le_u32 vcc, 6, v4
    v_mfma_f32_16x16x32_bf16 v[220:223], a[128:131], v[180:183], v[220:223]
    buffer_load_dwordx4 v116, s[28:31], s69 offen offset:1024 sc1 lds
    s_lshr_b32 s63, s61, 1
    s_mul_i32 s63, s63, 4032
    v_mfma_f32_16x16x32_bf16 v[236:239], a[132:135], v[176:179], v[236:239]
    s_add_u32 s63, s63, 141312
    v_cndmask_b32_e64 v6, v6, v7, vcc
    v_add_u32 v69, s63, v6
    v_lshlrev_b32 v7, 4, v13
    v_mfma_f32_16x16x32_bf16 v[216:219], a[128:131], v[176:179], v[216:219]
    s_mov_b32 exec_hi, 0
    buffer_load_dwordx4 v116, s[28:31], s69 offen offset:2048 sc1 lds
    s_mov_b32 exec_hi, -1
    s_waitcnt lgkmcnt(0)
    v_mfma_f32_16x16x32_bf16 v[252:255], a[124:127], v[212:215], v[252:255]
    ds_read_b128 a[116:119], v154 offset:0
    v_add_u32 v7, 141312, v7
    v_mfma_f32_16x16x32_bf16 v[232:235], a[120:123], v[212:215], v[232:235]
    ds_read_b128 v[192:195], v148 offset:0
    v_cmp_le_u32 vcc, 18, v60
    s_nop 1
    v_addc_co_u32 v4, vcc, 0, v60, vcc
    v_mfma_f32_16x16x32_bf16 v[248:251], a[124:127], v[208:211], v[248:251]
    ds_read_b128 a[112:115], v154 offset:2048
    v_mad_u32_u24 v72, v4, s64, v7
    v_cmp_le_u32 vcc, 14, v60
    v_mfma_f32_16x16x32_bf16 v[228:231], a[120:123], v[208:211], v[228:231]
    ds_read_b128 v[188:191], v148 offset:2048
    v_addc_co_u32 v4, vcc, 4, v60, vcc
    v_mad_u32_u24 v73, v4, s64, v7
    v_mfma_f32_16x16x32_bf16 v[244:247], a[124:127], v[204:207], v[244:247]
    ds_read_b128 v[184:187], v148 offset:4096
    s_mov_b32 s36, 0
    s_mov_b32 s37, 0xffff0000
    v_mfma_f32_16x16x32_bf16 v[224:227], a[120:123], v[204:207], v[224:227]
    ds_read_b128 v[180:183], v148 offset:6144
    s_mov_b32 s38, 0
    s_mov_b32 s39, -1
    v_mfma_f32_16x16x32_bf16 v[240:243], a[124:127], v[200:203], v[240:243]
    ds_read_b128 v[176:179], v150 offset:4096
    v_lshrrev_b32 v4, 1, v12
    v_and_b32 v4, 2, v4
    v_mfma_f32_16x16x32_bf16 v[220:223], a[120:123], v[200:203], v[220:223]
    v_and_b32 v6, 1, v12
    v_add3_u32 v4, v4, v6, 33
    v_mad_u32_u24 v6, v6, 19, 18
    v_mfma_f32_16x16x32_bf16 v[236:239], a[124:127], v[196:199], v[236:239]
    v_cmp_gt_u32 vcc, 2, v61
    s_nop 1
    v_cndmask_b32_e64 v4, v4, v6, vcc
    v_mad_u32_u24 v74, v4, s64, v7
    v_mfma_f32_16x16x32_bf16 v[216:219], a[120:123], v[196:199], v[216:219]
    s_waitcnt vmcnt(16) lgkmcnt(0)
    s_barrier
    s_mul_i32 s63, s61, 6400
    s_add_u32 s63, s63, 110592
    v_mfma_f32_16x16x32_bf16 v[252:255], a[116:119], v[192:195], v[252:255]
    ds_read_b128 v[212:215], v118 offset:32768
    v_mul_u32_u24 v70, 80, v12
    v_lshl_add_u32 v70, v13, 4, v70
    v_mfma_f32_16x16x32_bf16 v[232:235], a[112:115], v[192:195], v[232:235]
    ds_read_b128 v[208:211], v118 offset:33792
    v_add_u32 v70, s63, v70
    v_mul_u32_u24 v4, 80, v62
    v_mfma_f32_16x16x32_bf16 v[248:251], a[116:119], v[188:191], v[248:251]
    ds_read_b128 v[204:207], v48 offset:34816
    v_lshl_add_u32 v4, v61, 4, v4
    v_add_u32 v4, s63, v4
    v_mfma_f32_16x16x32_bf16 v[228:231], a[112:115], v[188:191], v[228:231]
    ds_read_b128 v[200:203], v118 offset:35840
    v_mul_u32_u24 v71, 1280, v13
    v_add_u32 v71, v71, v4
    v_mfma_f32_16x16x32_bf16 v[244:247], a[116:119], v[184:187], v[244:247]
    ds_read_b128 v[196:199], v118 offset:36864
    v_lshl_add_u32 v75, v3, 3, v4
    s_movk_i32 s40, 18432
    v_mfma_f32_16x16x32_bf16 v[224:227], a[112:115], v[184:187], v[224:227]
    s_mov_b32 s41, 36864
    s_mul_i32 s63, s62, 73728
    s_mul_i32 s64, s60, 2304
    s_add_u32 s63, s63, s64
    v_mfma_f32_16x16x32_bf16 v[240:243], a[116:119], v[180:183], v[240:243]
    s_add_u32 s63, s63, 4194304
    v_add_u32 v76, s63, v10
    v_lshl_add_u32 v6, v12, 4, s63
    v_mad_u32_u24 v6, v3, s41, v6
    v_mfma_f32_16x16x32_bf16 v[220:223], a[112:115], v[180:183], v[220:223]
    v_cmp_gt_u32 vcc, 2, v13
    s_mul_i32 s63, s62, 36864
    s_add_u32 s63, s63, 9437184
    v_mfma_f32_16x16x32_bf16 v[236:239], a[116:119], v[176:179], v[236:239]
    v_cndmask_b32_e64 v77, v11, v6, vcc
    s_lshl_b32 s64, s60, 10
    s_add_u32 s64, s64, s63
    v_mfma_f32_16x16x32_bf16 v[216:219], a[112:115], v[176:179], v[216:219]
    s_waitcnt lgkmcnt(0)
    v_mfma_f32_16x16x32_bf16 v[172:175], v[212:215], a[252:255], 0
    ds_read_b128 v[192:195], v118 offset:37888
    v_mfma_f32_16x16x32_bf16 v[168:171], v[212:215], a[248:251], 0
    ds_read_b128 v[188:191], v118 offset:38912
    v_mfma_f32_16x16x32_bf16 v[164:167], v[208:211], a[252:255], 0
    ds_read_b128 v[184:187], v48 offset:39936
    v_fma_f32 v133, v128, v252, v253
    v_mfma_f32_16x16x32_bf16 v[160:163], v[208:211], a[248:251], 0
    ds_read_b128 v[180:183], v118 offset:40960
    v_fma_f32 v134, v130, v248, v249
    v_mfma_f32_16x16x32_bf16 v[156:159], v[204:207], a[252:255], 0
    ds_read_b128 v[176:179], v118 offset:41984
    v_fma_f32 v135, v124, v244, v245
    v_mfma_f32_16x16x32_bf16 v[16:19], v[204:207], a[248:251], 0
    s_mul_i32 s69, s80, 80
    s_add_u32 m0, s19, 77824
    v_fma_f32 v112, v126, v240, v241
    v_mfma_f32_16x16x32_bf16 v[152:155], v[200:203], a[252:255], 0
    buffer_load_dwordx4 v116, s[28:31], s69 offen sc1 lds
    v_fma_f32 v113, v120, v236, v237
    v_mfma_f32_16x16x32_bf16 v[148:151], v[200:203], a[248:251], 0
    v_fmac_f32_dpp v133, v252, v129 row_ror:8 row_mask:0xf bank_mask:0xf
    v_fmac_f32_dpp v134, v248, v131 row_ror:8 row_mask:0xf bank_mask:0xf
    v_mfma_f32_16x16x32_bf16 v[144:147], v[196:199], a[252:255], 0
    buffer_load_dwordx4 v116, s[28:31], s69 offen offset:1024 sc1 lds
    v_fmac_f32_dpp v135, v244, v125 row_ror:8 row_mask:0xf bank_mask:0xf
    v_mfma_f32_16x16x32_bf16 v[140:143], v[196:199], a[248:251], 0
    s_waitcnt lgkmcnt(0)
    v_fmac_f32_dpp v112, v240, v127 row_ror:8 row_mask:0xf bank_mask:0xf
    v_fmac_f32_dpp v113, v236, v121 row_ror:8 row_mask:0xf bank_mask:0xf
    v_mfma_f32_16x16x32_bf16 v[172:175], v[192:195], a[244:247], v[172:175]
    ds_read_b128 v[212:215], v118 offset:43008
    v_fma_f32 v136, v128, v133, v254
    v_mfma_f32_16x16x32_bf16 v[168:171], v[192:195], a[240:243], v[168:171]
    ds_read_b128 v[208:211], v118 offset:44032
    v_fma_f32 v137, v130, v134, v250
    v_mfma_f32_16x16x32_bf16 v[164:167], v[188:191], a[244:247], v[164:167]
    ds_read_b128 v[204:207], v48 offset:45056
    v_fma_f32 v138, v124, v135, v246
    v_mfma_f32_16x16x32_bf16 v[160:163], v[188:191], a[240:243], v[160:163]
    ds_read_b128 v[200:203], v118 offset:46080
    v_fma_f32 v139, v126, v112, v242
    v_mfma_f32_16x16x32_bf16 v[156:159], v[184:187], a[244:247], v[156:159]
    ds_read_b128 v[196:199], v118 offset:47104
    v_fma_f32 v132, v120, v113, v238
    v_mfma_f32_16x16x32_bf16 v[16:19], v[184:187], a[240:243], v[16:19]
    s_mov_b32 exec_hi, 0
    buffer_load_dwordx4 v116, s[28:31], s69 offen offset:2048 sc1 lds
    s_mov_b32 exec_hi, -1
    v_mfma_f32_16x16x32_bf16 v[152:155], v[180:183], a[244:247], v[152:155]
    v_fmac_f32_dpp v136, v133, v129 row_ror:8 row_mask:0xf bank_mask:0xf
    v_fmac_f32_dpp v137, v134, v131 row_ror:8 row_mask:0xf bank_mask:0xf
    v_mfma_f32_16x16x32_bf16 v[148:151], v[180:183], a[240:243], v[148:151]
    v_fmac_f32_dpp v138, v135, v125 row_ror:8 row_mask:0xf bank_mask:0xf
    v_fmac_f32_dpp v139, v112, v127 row_ror:8 row_mask:0xf bank_mask:0xf
    v_mfma_f32_16x16x32_bf16 v[144:147], v[176:179], a[244:247], v[144:147]
    v_fmac_f32_dpp v132, v113, v121 row_ror:8 row_mask:0xf bank_mask:0xf
    v_fma_f32 v133, v128, v136, v255
    v_mfma_f32_16x16x32_bf16 v[140:143], v[176:179], a[240:243], v[140:143]
    s_waitcnt lgkmcnt(0)
    v_fma_f32 v134, v130, v137, v251
    v_fma_f32 v135, v124, v138, v247
    v_mfma_f32_16x16x32_bf16 v[172:175], v[212:215], a[236:239], v[172:175]
    ds_read_b128 v[192:195], v118 offset:48128
    v_fma_f32 v112, v126, v139, v243
    v_mfma_f32_16x16x32_bf16 v[168:171], v[212:215], a[232:235], v[168:171]
    ds_read_b128 v[188:191], v118 offset:49152
    v_fma_f32 v113, v120, v132, v239
    v_mfma_f32_16x16x32_bf16 v[164:167], v[208:211], a[236:239], v[164:167]
    ds_read_b128 v[184:187], v48 offset:50176
    v_fmac_f32_dpp v133, v136, v129 row_ror:8 row_mask:0xf bank_mask:0xf
    v_mfma_f32_16x16x32_bf16 v[160:163], v[208:211], a[232:235], v[160:163]
    ds_read_b128 v[180:183], v118 offset:51200
    v_fmac_f32_dpp v134, v137, v131 row_ror:8 row_mask:0xf bank_mask:0xf
    v_mfma_f32_16x16x32_bf16 v[156:159], v[204:207], a[236:239], v[156:159]
    ds_read_b128 v[176:179], v118 offset:52224
    v_fmac_f32_dpp v135, v138, v125 row_ror:8 row_mask:0xf bank_mask:0xf
    v_mfma_f32_16x16x32_bf16 v[16:19], v[204:207], a[232:235], v[16:19]
    s_mul_i32 s69, s81, 80
    s_add_u32 m0, s19, 88064
    v_fmac_f32_dpp v112, v139, v127 row_ror:8 row_mask:0xf bank_mask:0xf
    v_mfma_f32_16x16x32_bf16 v[152:155], v[200:203], a[236:239], v[152:155]
    buffer_load_dwordx4 v116, s[28:31], s69 offen sc1 lds
    v_fmac_f32_dpp v113, v132, v121 row_ror:8 row_mask:0xf bank_mask:0xf
    v_mfma_f32_16x16x32_bf16 v[148:151], v[200:203], a[232:235], v[148:151]
    v_fma_f32 v136, v128, v133, v232
    v_fma_f32 v137, v130, v134, v228
    v_mfma_f32_16x16x32_bf16 v[144:147], v[196:199], a[236:239], v[144:147]
    buffer_load_dwordx4 v116, s[28:31], s69 offen offset:1024 sc1 lds
    v_fma_f32 v138, v124, v135, v224
    v_mfma_f32_16x16x32_bf16 v[140:143], v[196:199], a[232:235], v[140:143]
    s_waitcnt vmcnt(15) lgkmcnt(0)
    s_barrier
    v_fma_f32 v139, v126, v112, v220
    v_mfma_f32_16x16x32_bf16 v[172:175], v[192:195], a[228:231], v[172:175]
    ds_read_b128 v[212:215], v118 offset:53248
    v_fma_f32 v132, v120, v113, v216
    v_mfma_f32_16x16x32_bf16 v[168:171], v[192:195], a[224:227], v[168:171]
    ds_read_b128 v[208:211], v118 offset:54272
    v_fmac_f32_dpp v136, v133, v129 row_ror:8 row_mask:0xf bank_mask:0xf
    v_mfma_f32_16x16x32_bf16 v[164:167], v[188:191], a[228:231], v[164:167]
    ds_read_b128 v[204:207], v48 offset:55296
    v_fmac_f32_dpp v137, v134, v131 row_ror:8 row_mask:0xf bank_mask:0xf
    v_mfma_f32_16x16x32_bf16 v[160:163], v[188:191], a[224:227], v[160:163]
    ds_read_b128 v[200:203], v118 offset:56320
    v_fmac_f32_dpp v138, v135, v125 row_ror:8 row_mask:0xf bank_mask:0xf
    v_mfma_f32_16x16x32_bf16 v[156:159], v[184:187], a[228:231], v[156:159]
    ds_read_b128 v[196:199], v118 offset:57344
    v_fmac_f32_dpp v139, v112, v127 row_ror:8 row_mask:0xf bank_mask:0xf
    v_mfma_f32_16x16x32_bf16 v[16:19], v[184:187], a[224:227], v[16:19]
    s_mov_b32 exec_hi, 0
    buffer_load_dwordx4 v116, s[28:31], s69 offen offset:2048 sc1 lds
    s_mov_b32 exec_hi, -1
    v_mfma_f32_16x16x32_bf16 v[152:155], v[180:183], a[228:231], v[152:155]
    v_fmac_f32_dpp v132, v113, v121 row_ror:8 row_mask:0xf bank_mask:0xf
    v_fma_f32 v133, v128, v136, v233
    v_mfma_f32_16x16x32_bf16 v[148:151], v[180:183], a[224:227], v[148:151]
    v_fma_f32 v134, v130, v137, v229
    v_fma_f32 v135, v124, v138, v225
    v_mfma_f32_16x16x32_bf16 v[144:147], v[176:179], a[228:231], v[144:147]
    v_fma_f32 v112, v126, v139, v221
    v_fma_f32 v113, v120, v132, v217
    v_mfma_f32_16x16x32_bf16 v[140:143], v[176:179], a[224:227], v[140:143]
    s_waitcnt lgkmcnt(0)
    v_fmac_f32_dpp v133, v136, v129 row_ror:8 row_mask:0xf bank_mask:0xf
    v_fmac_f32_dpp v134, v137, v131 row_ror:8 row_mask:0xf bank_mask:0xf
    v_mfma_f32_16x16x32_bf16 v[172:175], v[212:215], a[220:223], v[172:175]
    ds_read_b128 v[192:195], v118 offset:58368
    v_fmac_f32_dpp v135, v138, v125 row_ror:8 row_mask:0xf bank_mask:0xf
    v_mfma_f32_16x16x32_bf16 v[168:171], v[212:215], a[216:219], v[168:171]
    ds_read_b128 v[188:191], v118 offset:59392
    v_fmac_f32_dpp v112, v139, v127 row_ror:8 row_mask:0xf bank_mask:0xf
    v_mfma_f32_16x16x32_bf16 v[164:167], v[208:211], a[220:223], v[164:167]
    ds_read_b128 v[184:187], v48 offset:60416
    v_fmac_f32_dpp v113, v132, v121 row_ror:8 row_mask:0xf bank_mask:0xf
    v_mfma_f32_16x16x32_bf16 v[160:163], v[208:211], a[216:219], v[160:163]
    ds_read_b128 v[180:183], v118 offset:61440
    v_fma_f32 v136, v128, v133, v234
    v_mfma_f32_16x16x32_bf16 v[156:159], v[204:207], a[220:223], v[156:159]
    ds_read_b128 v[176:179], v118 offset:62464
    v_fma_f32 v137, v130, v134, v230
    v_mfma_f32_16x16x32_bf16 v[16:19], v[204:207], a[216:219], v[16:19]
    buffer_load_dword v80, v119, s[28:31], 0 offen offset:128 sc1
    v_fma_f32 v138, v124, v135, v226
    v_mfma_f32_16x16x32_bf16 v[152:155], v[200:203], a[220:223], v[152:155]
    v_fma_f32 v139, v126, v112, v222
    v_fma_f32 v132, v120, v113, v218
    v_mfma_f32_16x16x32_bf16 v[148:151], v[200:203], a[216:219], v[148:151]
    v_fmac_f32_dpp v136, v133, v129 row_ror:8 row_mask:0xf bank_mask:0xf
    v_fmac_f32_dpp v137, v134, v131 row_ror:8 row_mask:0xf bank_mask:0xf
    v_mfma_f32_16x16x32_bf16 v[144:147], v[196:199], a[220:223], v[144:147]
    s_lshl_b32 s69, s73, 5
    s_add_u32 m0, s22, 0
    v_fmac_f32_dpp v138, v135, v125 row_ror:8 row_mask:0xf bank_mask:0xf
    v_mfma_f32_16x16x32_bf16 v[140:143], v[196:199], a[216:219], v[140:143]
    s_waitcnt lgkmcnt(0)
    v_fmac_f32_dpp v139, v112, v127 row_ror:8 row_mask:0xf bank_mask:0xf
    v_fmac_f32_dpp v132, v113, v121 row_ror:8 row_mask:0xf bank_mask:0xf
    v_mfma_f32_16x16x32_bf16 v[172:175], v[192:195], a[212:215], v[172:175]
    ds_read_b128 v[212:215], v10 offset:16384
    v_fma_f32 v133, v128, v136, v235
    v_mfma_f32_16x16x32_bf16 v[168:171], v[192:195], a[208:211], v[168:171]
    ds_read_b128 v[208:211], v10 offset:17408
    v_fma_f32 v134, v130, v137, v231
    v_mfma_f32_16x16x32_bf16 v[164:167], v[188:191], a[212:215], v[164:167]
    ds_read_b128 v[204:207], v65 offset:18432
    v_fma_f32 v135, v124, v138, v227
    v_mfma_f32_16x16x32_bf16 v[160:163], v[188:191], a[208:211], v[160:163]
    ds_read_b128 v[200:203], v10 offset:19456
    v_fma_f32 v112, v126, v139, v223
    v_mfma_f32_16x16x32_bf16 v[156:159], v[184:187], a[212:215], v[156:159]
    ds_read_b128 v[196:199], v10 offset:20480
    v_fma_f32 v113, v120, v132, v219
    v_mfma_f32_16x16x32_bf16 v[16:19], v[184:187], a[208:211], v[16:19]
    buffer_load_dwordx4 v117, s[28:31], s69 offen sc1 lds
    v_fmac_f32_dpp v133, v136, v129 row_ror:8 row_mask:0xf bank_mask:0xf
    v_mfma_f32_16x16x32_bf16 v[152:155], v[180:183], a[212:215], v[152:155]
    s_lshl_b32 s69, s74, 5
    s_add_u32 m0, s22, 4096
    v_fmac_f32_dpp v134, v137, v131 row_ror:8 row_mask:0xf bank_mask:0xf
    v_mfma_f32_16x16x32_bf16 v[148:151], v[180:183], a[208:211], v[148:151]
    buffer_load_dwordx4 v117, s[28:31], s69 offen sc1 lds
    v_fmac_f32_dpp v135, v138, v125 row_ror:8 row_mask:0xf bank_mask:0xf
    v_mfma_f32_16x16x32_bf16 v[144:147], v[176:179], a[212:215], v[144:147]
    v_fmac_f32_dpp v112, v139, v127 row_ror:8 row_mask:0xf bank_mask:0xf
    v_fmac_f32_dpp v113, v132, v121 row_ror:8 row_mask:0xf bank_mask:0xf
    v_mfma_f32_16x16x32_bf16 v[140:143], v[176:179], a[208:211], v[140:143]
    s_waitcnt lgkmcnt(0)
    ds_write_b32 v45, v133 offset:0
    v_mfma_f32_16x16x32_bf16 v[172:175], v[212:215], a[204:207], v[172:175]
    ds_read_b128 v[192:195], v10 offset:21504
    v_mfma_f32_16x16x32_bf16 v[168:171], v[212:215], a[200:203], v[168:171]
    ds_read_b128 v[188:191], v10 offset:22528
    v_mfma_f32_16x16x32_bf16 v[164:167], v[208:211], a[204:207], v[164:167]
    ds_read_b128 v[184:187], v65 offset:23552
    v_mfma_f32_16x16x32_bf16 v[160:163], v[208:211], a[200:203], v[160:163]
    ds_read_b128 v[180:183], v10 offset:24576
    v_mfma_f32_16x16x32_bf16 v[156:159], v[204:207], a[204:207], v[156:159]
    ds_read_b128 v[176:179], v10 offset:25600
    v_mfma_f32_16x16x32_bf16 v[16:19], v[204:207], a[200:203], v[16:19]
    s_lshl_b32 s69, s75, 5
    s_add_u32 m0, s22, 8192
    v_mfma_f32_16x16x32_bf16 v[152:155], v[200:203], a[204:207], v[152:155]
    buffer_load_dwordx4 v117, s[28:31], s69 offen sc1 lds
    v_mfma_f32_16x16x32_bf16 v[148:151], v[200:203], a[200:203], v[148:151]
    ds_write_b32 v45, v134 offset:64
    v_mfma_f32_16x16x32_bf16 v[144:147], v[196:199], a[204:207], v[144:147]
    s_lshl_b32 s69, s76, 5
    s_add_u32 m0, s22, 12288
    v_mfma_f32_16x16x32_bf16 v[140:143], v[196:199], a[200:203], v[140:143]
    ds_write_b32 v45, v135 offset:128
    ds_write_b32 v45, v112 offset:192
    ds_write_b32 v45, v113 offset:256
    ds_read2_b64 v[108:111], v44 offset0:0 offset1:40
    ds_read2_b64 v[104:107], v44 offset0:80 offset1:120
    s_waitcnt lgkmcnt(0)
    v_fma_f32 v20, v108, v34, v110
    v_fma_f32 v21, v109, v34, v111
    v_fma_f32 v20, -v109, v35, v20
    v_fmac_f32 v21, v108, v35
    v_fma_f32 v22, v20, v34, v104
    v_fma_f32 v23, v21, v34, v105
    v_fma_f32 v22, -v21, v35, v22
    v_fmac_f32 v23, v20, v35
    v_fma_f32 v20, v22, v34, v106
    v_fma_f32 v21, v23, v34, v107
    v_fma_f32 v20, -v23, v35, v20
    v_fmac_f32 v21, v22, v35
    ds_write_b64 v46, v[20:21] offset:24
    s_waitcnt vmcnt(14) lgkmcnt(0)
    s_barrier
    v_mfma_f32_16x16x32_bf16 v[172:175], v[192:195], a[196:199], v[172:175]
    ds_read_b128 v[212:215], v10 offset:26624
    v_mfma_f32_16x16x32_bf16 v[168:171], v[192:195], a[192:195], v[168:171]
    ds_read_b128 v[208:211], v10 offset:27648
    v_mfma_f32_16x16x32_bf16 v[164:167], v[188:191], a[196:199], v[164:167]
    ds_read_b128 v[204:207], v65 offset:28672
    v_mfma_f32_16x16x32_bf16 v[160:163], v[188:191], a[192:195], v[160:163]
    ds_read_b128 v[200:203], v10 offset:29696
    v_mfma_f32_16x16x32_bf16 v[156:159], v[184:187], a[196:199], v[156:159]
    ds_read_b128 v[196:199], v10 offset:30720
    v_mfma_f32_16x16x32_bf16 v[16:19], v[184:187], a[192:195], v[16:19]
    buffer_load_dwordx4 v117, s[28:31], s69 offen sc1 lds
    v_mfma_f32_16x16x32_bf16 v[152:155], v[180:183], a[196:199], v[152:155]
    s_lshl_b32 s69, s77, 5
    s_add_u32 m0, s22, 57344
    v_mfma_f32_16x16x32_bf16 v[148:151], v[180:183], a[192:195], v[148:151]
    buffer_load_dwordx4 v117, s[28:31], s69 offen sc1 lds
    v_mfma_f32_16x16x32_bf16 v[144:147], v[176:179], a[196:199], v[144:147]
    ds_read2_b64 v[136:139], v46 offset0:0 offset1:1
    v_mfma_f32_16x16x32_bf16 v[140:143], v[176:179], a[192:195], v[140:143]
    s_waitcnt lgkmcnt(1)
    ds_read_b64 v[132:133], v46 offset:16
    v_mfma_f32_16x16x32_bf16 v[172:175], v[212:215], a[188:191], v[172:175]
    ds_read_b128 v[192:195], v10 offset:31744
    v_mov_b32 v22, v14
    v_mfma_f32_16x16x32_bf16 v[168:171], v[212:215], a[184:187], v[168:171]
    ds_read_b128 v[188:191], v10 offset:32768
    v_mov_b32 v23, v14
    v_mfma_f32_16x16x32_bf16 v[164:167], v[208:211], a[188:191], v[164:167]
    ds_read_b128 v[184:187], v65 offset:33792
    v_mfma_f32_16x16x32_bf16 v[160:163], v[208:211], a[184:187], v[160:163]
    ds_read_b128 v[180:183], v10 offset:34816
    v_mfma_f32_16x16x32_bf16 v[156:159], v[204:207], a[188:191], v[156:159]
    ds_read_b128 v[176:179], v10 offset:35840
    v_mfma_f32_16x16x32_bf16 v[16:19], v[204:207], a[184:187], v[16:19]
    s_lshl_b32 s69, s78, 5
    s_add_u32 m0, s22, 61440
    v_mfma_f32_16x16x32_bf16 v[152:155], v[200:203], a[188:191], v[152:155]
    buffer_load_dwordx4 v117, s[28:31], s69 offen sc1 lds
    s_waitcnt lgkmcnt(5)
    v_mfma_f32_16x16x32_bf16 v[148:151], v[200:203], a[184:187], v[148:151]
    v_fma_f32 v138, v136, v36, v138
    v_fma_f32 v139, v137, v36, v139
    v_mfma_f32_16x16x32_bf16 v[144:147], v[196:199], a[188:191], v[144:147]
    s_lshl_b32 s69, s79, 5
    s_add_u32 m0, s22, 65536
    v_fma_f32 v138, -v137, v37, v138
    v_mfma_f32_16x16x32_bf16 v[140:143], v[196:199], a[184:187], v[140:143]
    s_waitcnt lgkmcnt(0)
    v_fmac_f32 v139, v136, v37
    v_fma_f32 v24, v138, v36, v132
    v_mfma_f32_16x16x32_bf16 v[172:175], v[192:195], a[180:183], v[172:175]
    ds_read_b128 v[212:215], v10 offset:36864
    v_fma_f32 v25, v139, v36, v133
    v_mfma_f32_16x16x32_bf16 v[168:171], v[192:195], a[176:179], v[168:171]
    ds_read_b128 v[208:211], v10 offset:37888
    v_fma_f32 v24, -v139, v37, v24
    v_mfma_f32_16x16x32_bf16 v[164:167], v[188:191], a[180:183], v[164:167]
    ds_read_b128 v[204:207], v65 offset:38912
    v_fmac_f32 v25, v138, v37
    v_mfma_f32_16x16x32_bf16 v[160:163], v[188:191], a[176:179], v[160:163]
    ds_read_b128 v[200:203], v10 offset:39936
    v_fma_f32 v20, v24, v36, v20
    v_mfma_f32_16x16x32_bf16 v[156:159], v[184:187], a[180:183], v[156:159]
    ds_read_b128 v[196:199], v10 offset:40960
    v_fma_f32 v21, v25, v36, v21
    v_mfma_f32_16x16x32_bf16 v[16:19], v[184:187], a[176:179], v[16:19]
    buffer_load_dwordx4 v117, s[28:31], s69 offen sc1 lds
    v_fma_f32 v20, -v25, v37, v20
    v_mfma_f32_16x16x32_bf16 v[152:155], v[180:183], a[180:183], v[152:155]
    s_lshl_b32 s69, s80, 5
    s_add_u32 m0, s22, 69632
    v_fmac_f32 v21, v24, v37
    v_mfma_f32_16x16x32_bf16 v[148:151], v[180:183], a[176:179], v[148:151]
    buffer_load_dwordx4 v117, s[28:31], s69 offen sc1 lds
    v_and_b32 v20, s27, v20
    v_mfma_f32_16x16x32_bf16 v[144:147], v[176:179], a[180:183], v[144:147]
    v_and_b32 v21, s27, v21
    v_mfma_f32_16x16x32_bf16 v[140:143], v[176:179], a[176:179], v[140:143]
    s_waitcnt lgkmcnt(0)
    buffer_store_dwordx4 v[20:23], v51, s[28:31], 0 offen sc1
    v_mfma_f32_16x16x32_bf16 v[172:175], v[212:215], a[172:175], v[172:175]
    ds_read_b128 v[192:195], v10 offset:41984
    v_mov_b32 v136, 0
    v_mfma_f32_16x16x32_bf16 v[168:171], v[212:215], a[168:171], v[168:171]
    ds_read_b128 v[188:191], v10 offset:43008
    v_mov_b32 v137, 0
    v_mfma_f32_16x16x32_bf16 v[164:167], v[208:211], a[172:175], v[164:167]
    ds_read_b128 v[184:187], v65 offset:44032
    v_mov_b32 v138, 0
    v_mfma_f32_16x16x32_bf16 v[160:163], v[208:211], a[168:171], v[160:163]
    ds_read_b128 v[180:183], v10 offset:45056
    v_mov_b32 v139, 0
    v_mfma_f32_16x16x32_bf16 v[156:159], v[204:207], a[172:175], v[156:159]
    ds_read_b128 v[176:179], v10 offset:46080
    v_lshlrev_b32 v1, 4, v0
    v_mfma_f32_16x16x32_bf16 v[16:19], v[204:207], a[168:171], v[16:19]
    s_lshl_b32 s69, s81, 5
    s_add_u32 m0, s22, 73728
    v_add_u32 v1, 141312, v1
    v_mfma_f32_16x16x32_bf16 v[152:155], v[200:203], a[172:175], v[152:155]
    buffer_load_dwordx4 v117, s[28:31], s69 offen sc1 lds
    v_mfma_f32_16x16x32_bf16 v[148:151], v[200:203], a[168:171], v[148:151]
    ds_write_b128 v1, v[136:139]
    v_mfma_f32_16x16x32_bf16 v[144:147], v[196:199], a[172:175], v[144:147]
    s_waitcnt vmcnt(10)
    v_cmp_ne_u32 s[50:51], v80, v14
    s_nop 0
    s_cmp_lg_u64 s[50:51], 0
    s_cbranch_scc1 L_spin_fc
L_back_fc:
    v_mfma_f32_16x16x32_bf16 v[140:143], v[196:199], a[168:171], v[140:143]
    s_waitcnt lgkmcnt(1)
    s_barrier
    v_mfma_f32_16x16x32_bf16 v[172:175], v[192:195], a[164:167], v[172:175]
    ds_read_b128 v[212:215], v10 offset:47104
    v_mfma_f32_16x16x32_bf16 v[168:171], v[192:195], a[160:163], v[168:171]
    ds_read_b128 v[208:211], v10 offset:48128
    v_mfma_f32_16x16x32_bf16 v[164:167], v[188:191], a[164:167], v[164:167]
    ds_read_b128 v[204:207], v65 offset:49152
    v_mfma_f32_16x16x32_bf16 v[160:163], v[188:191], a[160:163], v[160:163]
    ds_read_b128 v[200:203], v10 offset:50176
    v_mfma_f32_16x16x32_bf16 v[156:159], v[184:187], a[164:167], v[156:159]
    ds_read_b128 v[196:199], v10 offset:51200
    v_mfma_f32_16x16x32_bf16 v[16:19], v[184:187], a[160:163], v[16:19]
    buffer_load_dwordx4 a[108:111], v32, s[28:31], s32 offen offset:0 sc1
    v_mfma_f32_16x16x32_bf16 v[152:155], v[180:183], a[164:167], v[152:155]
    ds_write_b128 v1, v[136:139] offset:4096
    v_mfma_f32_16x16x32_bf16 v[148:151], v[180:183], a[160:163], v[148:151]
    v_add_u32 v78, s64, v10
    s_lshl_b32 s64, s60, 7
    v_mfma_f32_16x16x32_bf16 v[144:147], v[176:179], a[164:167], v[144:147]
    s_add_u32 s64, s64, s63
    s_add_u32 s64, s64, 16384
    v_lshl_add_u32 v6, v12, 3, s64
    v_mfma_f32_16x16x32_bf16 v[140:143], v[176:179], a[160:163], v[140:143]
    s_waitcnt lgkmcnt(1)
    v_lshl_add_u32 v6, v3, 2, v6
    v_mad_u32_u24 v79, v5, s40, v6
    v_mfma_f32_16x16x32_bf16 v[172:175], v[212:215], a[156:159], v[172:175]
    ds_read_b128 v[192:195], v10 offset:52224
    s_mov_b32 s42, 1069066811
    v_mfma_f32_16x16x32_bf16 v[168:171], v[212:215], a[152:155], v[168:171]
    ds_read_b128 v[188:191], v10 offset:53248
    s_mov_b32 s43, 1069066811
    v_mfma_f32_16x16x32_bf16 v[164:167], v[208:211], a[156:159], v[164:167]
    ds_read_b128 v[184:187], v65 offset:54272
    s_lshr_b32 s63, s61, 1
    v_mfma_f32_16x16x32_bf16 v[160:163], v[208:211], a[152:155], v[160:163]
    ds_read_b128 v[180:183], v10 offset:55296
    s_mul_i32 s63, s63, 28672
    v_mfma_f32_16x16x32_bf16 v[156:159], v[204:207], a[156:159], v[156:159]
    ds_read_b128 v[176:179], v10 offset:56320
    s_lshl_b32 s48, s61, 14
    v_mfma_f32_16x16x32_bf16 v[16:19], v[204:207], a[152:155], v[16:19]
    buffer_load_dwordx4 a[104:107], v32, s[28:31], s32 offen offset:1024 sc1
    s_add_u32 s48, s48, s63
    v_mfma_f32_16x16x32_bf16 v[152:155], v[200:203], a[156:159], v[152:155]
    s_add_u32 s48, s48, 16384
    v_mfma_f32_16x16x32_bf16 v[148:151], v[200:203], a[152:155], v[148:151]
    v_mfma_f32_16x16x32_bf16 v[144:147], v[196:199], a[156:159], v[144:147]
    buffer_load_dwordx4 a[100:103], v32, s[28:31], s32 offen offset:2048 sc1
    v_mfma_f32_16x16x32_bf16 v[140:143], v[196:199], a[152:155], v[140:143]
    s_waitcnt lgkmcnt(0)
    v_mfma_f32_16x16x32_bf16 v[172:175], v[192:195], a[148:151], v[172:175]
    ds_read_b128 v[212:215], v118 offset:0
    v_mfma_f32_16x16x32_bf16 v[168:171], v[192:195], a[144:147], v[168:171]
    ds_read_b128 v[208:211], v118 offset:1024
    v_mfma_f32_16x16x32_bf16 v[164:167], v[188:191], a[148:151], v[164:167]
    ds_read_b128 v[204:207], v48 offset:2048
    v_mfma_f32_16x16x32_bf16 v[160:163], v[188:191], a[144:147], v[160:163]
    ds_read_b128 v[200:203], v118 offset:3072
    v_mfma_f32_16x16x32_bf16 v[156:159], v[184:187], a[148:151], v[156:159]
    ds_read_b128 v[196:199], v118 offset:4096
    v_mfma_f32_16x16x32_bf16 v[16:19], v[184:187], a[144:147], v[16:19]
    buffer_load_dwordx4 a[96:99], v32, s[28:31], s32 offen offset:3072 sc1
    v_mfma_f32_16x16x32_bf16 v[152:155], v[180:183], a[148:151], v[152:155]
    v_mfma_f32_16x16x32_bf16 v[148:151], v[180:183], a[144:147], v[148:151]
    v_mfma_f32_16x16x32_bf16 v[144:147], v[176:179], a[148:151], v[144:147]
    v_mfma_f32_16x16x32_bf16 v[140:143], v[176:179], a[144:147], v[140:143]
    s_waitcnt lgkmcnt(0)
    v_mfma_f32_16x16x32_bf16 v[172:175], v[212:215], a[140:143], v[172:175]
    ds_read_b128 v[192:195], v118 offset:5120
    v_mfma_f32_16x16x32_bf16 v[168:171], v[212:215], a[136:139], v[168:171]
    ds_read_b128 v[188:191], v118 offset:6144
    v_mfma_f32_16x16x32_bf16 v[164:167], v[208:211], a[140:143], v[164:167]
    ds_read_b128 v[184:187], v48 offset:7168
    v_mfma_f32_16x16x32_bf16 v[160:163], v[208:211], a[136:139], v[160:163]
    ds_read_b128 v[180:183], v118 offset:8192
    v_mfma_f32_16x16x32_bf16 v[156:159], v[204:207], a[140:143], v[156:159]
    ds_read_b128 v[176:179], v118 offset:9216
    v_mfma_f32_16x16x32_bf16 v[16:19], v[204:207], a[136:139], v[16:19]
    buffer_load_dwordx4 a[92:95], v33, s[28:31], s32 offen sc1
    v_mfma_f32_16x16x32_bf16 v[152:155], v[200:203], a[140:143], v[152:155]
    v_mfma_f32_16x16x32_bf16 v[148:151], v[200:203], a[136:139], v[148:151]
    v_mfma_f32_16x16x32_bf16 v[144:147], v[196:199], a[140:143], v[144:147]
    s_add_u32 s32, s32, 4608
    v_mfma_f32_16x16x32_bf16 v[140:143], v[196:199], a[136:139], v[140:143]
    s_waitcnt lgkmcnt(0)
    v_mfma_f32_16x16x32_bf16 v[172:175], v[192:195], a[132:135], v[172:175]
    ds_read_b128 v[212:215], v118 offset:10240
    v_mfma_f32_16x16x32_bf16 v[168:171], v[192:195], a[128:131], v[168:171]
    ds_read_b128 v[208:211], v118 offset:11264
    v_mfma_f32_16x16x32_bf16 v[164:167], v[188:191], a[132:135], v[164:167]
    ds_read_b128 v[204:207], v48 offset:12288
    v_mfma_f32_16x16x32_bf16 v[160:163], v[188:191], a[128:131], v[160:163]
    ds_read_b128 v[200:203], v118 offset:13312
    v_mfma_f32_16x16x32_bf16 v[156:159], v[184:187], a[132:135], v[156:159]
    ds_read_b128 v[196:199], v118 offset:14336
    v_mfma_f32_16x16x32_bf16 v[16:19], v[184:187], a[128:131], v[16:19]
    buffer_load_dwordx4 a[88:91], v32, s[28:31], s32 offen offset:0 sc1
    v_mfma_f32_16x16x32_bf16 v[152:155], v[180:183], a[132:135], v[152:155]
    buffer_load_dwordx4 a[84:87], v32, s[28:31], s32 offen offset:1024 sc1
    v_mfma_f32_16x16x32_bf16 v[148:151], v[180:183], a[128:131], v[148:151]
    v_mfma_f32_16x16x32_bf16 v[144:147], v[176:179], a[132:135], v[144:147]
    v_mfma_f32_16x16x32_bf16 v[140:143], v[176:179], a[128:131], v[140:143]
    s_waitcnt lgkmcnt(0)
    v_mfma_f32_16x16x32_bf16 v[172:175], v[212:215], a[124:127], v[172:175]
    ds_read_b128 v[192:195], v118 offset:15360
    v_mfma_f32_16x16x32_bf16 v[168:171], v[212:215], a[120:123], v[168:171]
    ds_read_b128 v[188:191], v118 offset:16384
    v_mfma_f32_16x16x32_bf16 v[164:167], v[208:211], a[124:127], v[164:167]
    ds_read_b128 v[184:187], v48 offset:17408
    v_mfma_f32_16x16x32_bf16 v[160:163], v[208:211], a[120:123], v[160:163]
    ds_read_b128 v[180:183], v118 offset:18432
    v_mfma_f32_16x16x32_bf16 v[156:159], v[204:207], a[124:127], v[156:159]
    ds_read_b128 v[176:179], v118 offset:19456
    v_mfma_f32_16x16x32_bf16 v[16:19], v[204:207], a[120:123], v[16:19]
    buffer_load_dwordx4 a[80:83], v32, s[28:31], s32 offen offset:2048 sc1
    v_mfma_f32_16x16x32_bf16 v[152:155], v[200:203], a[124:127], v[152:155]
    v_mfma_f32_16x16x32_bf16 v[148:151], v[200:203], a[120:123], v[148:151]
    v_mfma_f32_16x16x32_bf16 v[144:147], v[196:199], a[124:127], v[144:147]
    buffer_load_dwordx4 a[76:79], v32, s[28:31], s32 offen offset:3072 sc1
    v_mfma_f32_16x16x32_bf16 v[140:143], v[196:199], a[120:123], v[140:143]
    s_waitcnt lgkmcnt(0)
    v_mfma_f32_16x16x32_bf16 v[172:175], v[192:195], a[116:119], v[172:175]
    v_mfma_f32_16x16x32_bf16 v[168:171], v[192:195], a[112:115], v[168:171]
    v_mfma_f32_16x16x32_bf16 v[164:167], v[188:191], a[116:119], v[164:167]
    v_mfma_f32_16x16x32_bf16 v[160:163], v[188:191], a[112:115], v[160:163]
    v_mfma_f32_16x16x32_bf16 v[156:159], v[184:187], a[116:119], v[156:159]
    buffer_load_dwordx4 a[72:75], v33, s[28:31], s32 offen sc1
    v_mfma_f32_16x16x32_bf16 v[16:19], v[184:187], a[112:115], v[16:19]
    v_mfma_f32_16x16x32_bf16 v[152:155], v[180:183], a[116:119], v[152:155]
    v_mfma_f32_16x16x32_bf16 v[148:151], v[180:183], a[112:115], v[148:151]
    v_mfma_f32_16x16x32_bf16 v[144:147], v[176:179], a[116:119], v[144:147]
    v_mfma_f32_16x16x32_bf16 v[140:143], v[176:179], a[112:115], v[140:143]
    v_permlane32_swap_b32 v172, v168
    v_permlane32_swap_b32 v173, v169
    v_permlane32_swap_b32 v174, v170
    v_permlane32_swap_b32 v175, v171
    v_permlane32_swap_b32 v164, v160
    v_permlane32_swap_b32 v165, v161
    v_permlane32_swap_b32 v166, v162
    v_permlane32_swap_b32 v167, v163
    buffer_load_dwordx4 v[212:215], v50, s[28:31], s23 offen sc1
    v_permlane32_swap_b32 v156, v16
    v_permlane32_swap_b32 v157, v17
    v_permlane32_swap_b32 v158, v18
    v_permlane32_swap_b32 v159, v19
    v_cvt_pk_bf16_f32 v152, v152, v153
    v_cvt_pk_bf16_f32 v153, v154, v155
    ds_write_b64 v53, v[152:153] offset:72
    v_cvt_pk_bf16_f32 v148, v148, v149
    v_cvt_pk_bf16_f32 v149, v150, v151
    ds_write_b64 v53, v[148:149] offset:3656
    v_cvt_pk_bf16_f32 v144, v144, v145
    v_cvt_pk_bf16_f32 v145, v146, v147
    ds_write_b64 v53, v[144:145] offset:88
    buffer_load_dwordx4 v[208:211], v50, s[28:31], s24 offen sc1
    v_cvt_pk_bf16_f32 v140, v140, v141
    v_cvt_pk_bf16_f32 v141, v142, v143
    ds_write_b64 v53, v[140:141] offset:3672
    v_cvt_pk_bf16_f32 v182, v158, v159
    v_mov_b32 v183, 0x3f80
    ds_write_b64 v52, v[182:183] offset:104
    v_max3_f32 v20, v172, v173, v174
    v_min3_f32 v21, v172, v173, v174
    v_max3_f32 v20, v20, v175, v168
    v_min3_f32 v21, v21, v175, v168
    v_max3_f32 v20, v20, v169, v170
    v_min3_f32 v21, v21, v169, v170
    v_max3_f32 v20, v20, v171, v164
    v_min3_f32 v21, v21, v171, v164
    v_max3_f32 v20, v20, v165, v166
    v_min3_f32 v21, v21, v165, v166
    v_max3_f32 v20, v20, v167, v160
    v_min3_f32 v21, v21, v167, v160
    v_max3_f32 v20, v20, v161, v162
    v_min3_f32 v21, v21, v161, v162
    buffer_load_dwordx4 v[204:207], v50, s[28:31], s25 offen sc1
    v_max3_f32 v20, v20, v163, v156
    v_min3_f32 v21, v21, v163, v156
    v_max_f32 v20, v20, v157
    v_min_f32 v21, v21, v157
    v_pk_mul_f32 v[20:21], v[20:21], s[42:43]
    v_pk_fma_f32 v[176:177], v[172:173], s[42:43], v[20:21] op_sel:[0,0,1] op_sel_hi:[1,1,1] neg_lo:[1,0,0] neg_hi:[1,0,0]
    v_pk_fma_f32 v[172:173], v[172:173], s[42:43], v[20:21] op_sel:[0,0,0] op_sel_hi:[1,1,0] neg_lo:[0,0,1] neg_hi:[0,0,1]
    v_pk_fma_f32 v[178:179], v[174:175], s[42:43], v[20:21] op_sel:[0,0,1] op_sel_hi:[1,1,1] neg_lo:[1,0,0] neg_hi:[1,0,0]
    v_pk_fma_f32 v[174:175], v[174:175], s[42:43], v[20:21] op_sel:[0,0,0] op_sel_hi:[1,1,0] neg_lo:[0,0,1] neg_hi:[0,0,1]
    v_pk_fma_f32 v[136:137], v[168:169], s[42:43], v[20:21] op_sel:[0,0,1] op_sel_hi:[1,1,1] neg_lo:[1,0,0] neg_hi:[1,0,0]
    v_pk_fma_f32 v[168:169], v[168:169], s[42:43], v[20:21] op_sel:[0,0,0] op_sel_hi:[1,1,0] neg_lo:[0,0,1] neg_hi:[0,0,1]
    v_pk_fma_f32 v[138:139], v[170:171], s[42:43], v[20:21] op_sel:[0,0,1] op_sel_hi:[1,1,1] neg_lo:[1,0,0] neg_hi:[1,0,0]
    v_pk_fma_f32 v[170:171], v[170:171], s[42:43], v[20:21] op_sel:[0,0,0] op_sel_hi:[1,1,0] neg_lo:[0,0,1] neg_hi:[0,0,1]
    v_pk_fma_f32 v[132:133], v[164:165], s[42:43], v[20:21] op_sel:[0,0,1] op_sel_hi:[1,1,1] neg_lo:[1,0,0] neg_hi:[1,0,0]
    v_pk_fma_f32 v[164:165], v[164:165], s[42:43], v[20:21] op_sel:[0,0,0] op_sel_hi:[1,1,0] neg_lo:[0,0,1] neg_hi:[0,0,1]
    v_pk_fma_f32 v[134:135], v[166:167], s[42:43], v[20:21] op_sel:[0,0,1] op_sel_hi:[1,1,1] neg_lo:[1,0,0] neg_hi:[1,0,0]
    v_pk_fma_f32 v[166:167], v[166:167], s[42:43], v[20:21] op_sel:[0,0,0] op_sel_hi:[1,1,0] neg_lo:[0,0,1] neg_hi:[0,0,1]
    v_pk_fma_f32 v[116:117], v[160:161], s[42:43], v[20:21] op_sel:[0,0,1] op_sel_hi:[1,1,1] neg_lo:[1,0,0] neg_hi:[1,0,0]
    v_pk_fma_f32 v[160:161], v[160:161], s[42:43], v[20:21] op_sel:[0,0,0] op_sel_hi:[1,1,0] neg_lo:[0,0,1] neg_hi:[0,0,1]
    v_pk_fma_f32 v[118:119], v[162:163], s[42:43], v[20:21] op_sel:[0,0,1] op_sel_hi:[1,1,1] neg_lo:[1,0,0] neg_hi:[1,0,0]
    v_pk_fma_f32 v[162:163], v[162:163], s[42:43], v[20:21] op_sel:[0,0,0] op_sel_hi:[1,1,0] neg_lo:[0,0,1] neg_hi:[0,0,1]
    v_pk_fma_f32 v[112:113], v[156:157], s[42:43], v[20:21] op_sel:[0,0,1] op_sel_hi:[1,1,1] neg_lo:[1,0,0] neg_hi:[1,0,0]
    v_pk_fma_f32 v[156:157], v[156:157], s[42:43], v[20:21] op_sel:[0,0,0] op_sel_hi:[1,1,0] neg_lo:[0,0,1] neg_hi:[0,0,1]
    v_exp_f32 v172, v172
    buffer_load_dwordx4 v[200:203], v50, s[28:31], s26 offen sc1
    v_exp_f32 v173, v173
    v_exp_f32 v174, v174
    v_exp_f32 v175, v175
    v_exp_f32 v168, v168
    v_exp_f32 v169, v169
    v_exp_f32 v170, v170
    v_exp_f32 v171, v171
    v_exp_f32 v164, v164
    v_exp_f32 v165, v165
    v_exp_f32 v166, v166
    v_exp_f32 v167, v167
    s_add_u32 s32, s32, 4608
    v_exp_f32 v160, v160
    buffer_load_dwordx4 a[68:71], v32, s[28:31], s32 offen offset:0 sc1
    v_exp_f32 v161, v161
    v_exp_f32 v162, v162
    v_exp_f32 v163, v163
    v_exp_f32 v156, v156
    v_exp_f32 v157, v157
    v_exp_f32 v176, v176
    v_exp_f32 v177, v177
    v_exp_f32 v178, v178
    v_exp_f32 v179, v179
    v_exp_f32 v136, v136
    v_exp_f32 v137, v137
    buffer_load_dwordx4 a[64:67], v32, s[28:31], s32 offen offset:1024 sc1
    v_exp_f32 v138, v138
    v_exp_f32 v139, v139
    v_exp_f32 v132, v132
    v_exp_f32 v133, v133
    v_exp_f32 v134, v134
    v_exp_f32 v135, v135
    v_exp_f32 v116, v116
    v_exp_f32 v117, v117
    v_exp_f32 v118, v118
    v_exp_f32 v119, v119
    v_exp_f32 v112, v112
    v_exp_f32 v113, v113
    buffer_load_dwordx4 a[60:63], v32, s[28:31], s32 offen offset:2048 sc1
    v_pk_add_f32 v[20:21], v[172:173], v[174:175]
    v_pk_add_f32 v[22:23], v[176:177], v[178:179]
    v_pk_add_f32 v[20:21], v[20:21], v[168:169]
    v_pk_add_f32 v[22:23], v[22:23], v[136:137]
    v_pk_add_f32 v[20:21], v[20:21], v[170:171]
    v_pk_add_f32 v[22:23], v[22:23], v[138:139]
    v_pk_add_f32 v[20:21], v[20:21], v[164:165]
    v_pk_add_f32 v[22:23], v[22:23], v[132:133]
    v_pk_add_f32 v[20:21], v[20:21], v[166:167]
    v_pk_add_f32 v[22:23], v[22:23], v[134:135]
    v_pk_add_f32 v[20:21], v[20:21], v[160:161]
    v_pk_add_f32 v[22:23], v[22:23], v[116:117]
    v_pk_add_f32 v[20:21], v[20:21], v[162:163]
    v_pk_add_f32 v[22:23], v[22:23], v[118:119]
    v_pk_add_f32 v[20:21], v[20:21], v[156:157]
    v_pk_add_f32 v[22:23], v[22:23], v[112:113]
    v_add_f32 v20, v20, v21
    v_add_f32 v21, v22, v23
    v_rcp_f32 v20, v20
    v_rcp_f32 v21, v21
    s_nop 0
    v_pk_mul_f32 v[172:173], v[172:173], v[20:21] op_sel:[0,0] op_sel_hi:[1,0]
    v_cvt_pk_bf16_f32 v196, v172, v173
    buffer_load_dwordx4 a[56:59], v32, s[28:31], s32 offen offset:3072 sc1
    v_pk_mul_f32 v[174:175], v[174:175], v[20:21] op_sel:[0,0] op_sel_hi:[1,0]
    v_cvt_pk_bf16_f32 v197, v174, v175
    v_pk_mul_f32 v[168:169], v[168:169], v[20:21] op_sel:[0,0] op_sel_hi:[1,0]
    v_cvt_pk_bf16_f32 v198, v168, v169
    v_pk_mul_f32 v[170:171], v[170:171], v[20:21] op_sel:[0,0] op_sel_hi:[1,0]
    v_cvt_pk_bf16_f32 v199, v170, v171
    ds_write_b128 v52, v[196:199] offset:0
    v_pk_mul_f32 v[164:165], v[164:165], v[20:21] op_sel:[0,0] op_sel_hi:[1,0]
    v_cvt_pk_bf16_f32 v192, v164, v165
    v_pk_mul_f32 v[166:167], v[166:167], v[20:21] op_sel:[0,0] op_sel_hi:[1,0]
    v_cvt_pk_bf16_f32 v193, v166, v167
    v_pk_mul_f32 v[160:161], v[160:161], v[20:21] op_sel:[0,0] op_sel_hi:[1,0]
    v_cvt_pk_bf16_f32 v194, v160, v161
    v_pk_mul_f32 v[162:163], v[162:163], v[20:21] op_sel:[0,0] op_sel_hi:[1,0]
    v_cvt_pk_bf16_f32 v195, v162, v163
    ds_write_b128 v52, v[192:195] offset:16
    buffer_load_dwordx4 a[52:55], v33, s[28:31], s32 offen sc1
    v_pk_mul_f32 v[156:157], v[156:157], v[20:21] op_sel:[0,0] op_sel_hi:[1,0]
    v_cvt_pk_bf16_f32 v188, v156, v157
    v_pk_mul_f32 v[176:177], v[176:177], v[20:21] op_sel:[0,1] op_sel_hi:[1,1]
    v_cvt_pk_bf16_f32 v189, v176, v177
    v_pk_mul_f32 v[178:179], v[178:179], v[20:21] op_sel:[0,1] op_sel_hi:[1,1]
    v_cvt_pk_bf16_f32 v190, v178, v179
    v_pk_mul_f32 v[136:137], v[136:137], v[20:21] op_sel:[0,1] op_sel_hi:[1,1]
    v_cvt_pk_bf16_f32 v191, v136, v137
    ds_write_b128 v52, v[188:191] offset:32
    v_pk_mul_f32 v[138:139], v[138:139], v[20:21] op_sel:[0,1] op_sel_hi:[1,1]
    v_cvt_pk_bf16_f32 v184, v138, v139
    v_pk_mul_f32 v[132:133], v[132:133], v[20:21] op_sel:[0,1] op_sel_hi:[1,1]
    v_cvt_pk_bf16_f32 v185, v132, v133
    v_pk_mul_f32 v[134:135], v[134:135], v[20:21] op_sel:[0,1] op_sel_hi:[1,1]
    v_cvt_pk_bf16_f32 v186, v134, v135
    v_pk_mul_f32 v[116:117], v[116:117], v[20:21] op_sel:[0,1] op_sel_hi:[1,1]
    s_add_u32 s32, s32, 4608
    v_cvt_pk_bf16_f32 v187, v116, v117
    buffer_load_dwordx4 a[48:51], v32, s[28:31], s32 offen offset:0 sc1
    ds_write_b128 v52, v[184:187] offset:48
    v_pk_mul_f32 v[118:119], v[118:119], v[20:21] op_sel:[0,1] op_sel_hi:[1,1]
    v_cvt_pk_bf16_f32 v180, v118, v119
    v_pk_mul_f32 v[112:113], v[112:113], v[20:21] op_sel:[0,1] op_sel_hi:[1,1]
    v_cvt_pk_bf16_f32 v181, v112, v113
    ds_write_b64 v52, v[180:181] offset:64
    s_waitcnt lgkmcnt(0)
    s_waitcnt vmcnt(20)
    s_barrier
    ds_read_b64_tr_b16 v[184:185], v55 offset:72
    ds_read_b64_tr_b16 v[186:187], v55 offset:3656
    ds_read_b64_tr_b16 v[196:197], v54 offset:0
    ds_read_b64_tr_b16 v[198:199], v54 offset:3584
    buffer_load_dwordx4 a[44:47], v32, s[28:31], s32 offen offset:1024 sc1
    ds_read_b64_tr_b16 v[192:193], v54 offset:24
    ds_read_b64_tr_b16 v[194:195], v54 offset:3608
    ds_read_b64_tr_b16 v[188:189], v54 offset:48
    ds_read_b64_tr_b16 v[190:191], v54 offset:3632
    ds_read_b64_tr_b16 v[168:169], v55 offset:7240
    ds_read_b64_tr_b16 v[170:171], v55 offset:10824
    ds_read_b64_tr_b16 v[180:181], v54 offset:7168
    ds_read_b64_tr_b16 v[182:183], v54 offset:10752
    ds_read_b64_tr_b16 v[176:177], v54 offset:7192
    ds_read_b64_tr_b16 v[178:179], v54 offset:10776
    ds_read_b64_tr_b16 v[172:173], v54 offset:7216
    ds_read_b64_tr_b16 v[174:175], v54 offset:10800
    s_waitcnt lgkmcnt(8)
    v_mfma_f32_16x16x32_bf16 v[132:135], v[196:199], v[184:187], 0
    ds_read_b64_tr_b16 v[152:153], v55 offset:14408
    ds_read_b64_tr_b16 v[154:155], v55 offset:17992
    ds_read_b64_tr_b16 v[164:165], v54 offset:14336
    v_mfma_f32_16x16x32_bf16 v[116:119], v[192:195], v[184:187], 0
    ds_read_b64_tr_b16 v[166:167], v54 offset:17920
    ds_read_b64_tr_b16 v[160:161], v54 offset:14360
    ds_read_b64_tr_b16 v[162:163], v54 offset:17944
    v_mfma_f32_16x16x32_bf16 v[112:115], v[188:191], v[184:187], 0
    ds_read_b64_tr_b16 v[156:157], v54 offset:14384
    ds_read_b64_tr_b16 v[158:159], v54 offset:17968
    s_waitcnt lgkmcnt(8)
    v_mfma_f32_16x16x32_bf16 v[132:135], v[180:183], v[168:171], v[132:135]
    ds_read_b64_tr_b16 v[136:137], v55 offset:21576
    ds_read_b64_tr_b16 v[138:139], v55 offset:25160
    ds_read_b64_tr_b16 v[148:149], v54 offset:21504
    v_mfma_f32_16x16x32_bf16 v[116:119], v[176:179], v[168:171], v[116:119]
    ds_read_b64_tr_b16 v[150:151], v54 offset:25088
    ds_read_b64_tr_b16 v[144:145], v54 offset:21528
    ds_read_b64_tr_b16 v[146:147], v54 offset:25112
    v_mfma_f32_16x16x32_bf16 v[112:115], v[172:175], v[168:171], v[112:115]
    ds_read_b64_tr_b16 v[140:141], v54 offset:21552
    ds_read_b64_tr_b16 v[142:143], v54 offset:25136
    s_waitcnt lgkmcnt(8)
    v_mfma_f32_16x16x32_bf16 v[132:135], v[164:167], v[152:155], v[132:135]
    buffer_load_dwordx4 a[40:43], v32, s[28:31], s32 offen offset:2048 sc1
    v_mfma_f32_16x16x32_bf16 v[116:119], v[160:163], v[152:155], v[116:119]
    v_mfma_f32_16x16x32_bf16 v[112:115], v[156:159], v[152:155], v[112:115]
    s_waitcnt lgkmcnt(0)
    v_mfma_f32_16x16x32_bf16 v[132:135], v[148:151], v[136:139], v[132:135]
    buffer_load_dwordx4 a[36:39], v32, s[28:31], s32 offen offset:3072 sc1
    v_mfma_f32_16x16x32_bf16 v[116:119], v[144:147], v[136:139], v[116:119]
    v_mfma_f32_16x16x32_bf16 v[112:115], v[140:143], v[136:139], v[112:115]
    v_mov_b32 v103, v14
    v_mov_b32 v99, v14
    v_add_u32 v15, 57344, v10
    ds_read_b128 v[180:183], v10 offset:0
    ds_read_b128 v[176:179], v10 offset:1024
    ds_read_b128 v[172:175], v10 offset:2048
    ds_read_b128 v[168:171], v10 offset:3072
    v_cvt_pk_bf16_f32 v100, v132, v133
    v_cvt_pk_bf16_f32 v101, v134, v135
    v_cvt_pk_bf16_f32 v102, v116, v117
    v_cvt_pk_bf16_f32 v96, v118, v119
    buffer_load_dwordx4 a[32:35], v33, s[28:31], s32 offen sc1
    v_cvt_pk_bf16_f32 v97, v112, v113
    v_cvt_pk_bf16_f32 v98, v114, v115
    buffer_store_dwordx4 v[100:103], v64, s[28:31], 0 offen sc1
    buffer_store_dwordx4 v[96:99], v67, s[28:31], 0 offen sc1
    s_waitcnt lgkmcnt(0)
    v_mfma_f32_16x16x32_bf16 v[196:199], v[180:183], a[252:255], 0
    ds_read_b128 v[164:167], v10 offset:4096
    s_waitcnt vmcnt(15)
    v_xor_b32 v1, v214, v14
    v_mfma_f32_16x16x32_bf16 v[192:195], v[180:183], a[248:251], 0
    ds_read_b128 v[160:163], v10 offset:5120
    s_waitcnt vmcnt(14)
    v_bitop3_b32 v1, v1, v210, v14 bitop3:0xf6
    v_mfma_f32_16x16x32_bf16 v[188:191], v[176:179], a[252:255], 0
    ds_read_b128 v[156:159], v10 offset:6144
    s_waitcnt vmcnt(13)
    v_bitop3_b32 v1, v1, v206, v14 bitop3:0xf6
    v_mfma_f32_16x16x32_bf16 v[184:187], v[176:179], a[248:251], 0
    ds_read_b128 v[152:155], v10 offset:7168
    s_waitcnt vmcnt(12)
    v_bitop3_b32 v1, v1, v202, v14 bitop3:0xf6
    v_mfma_f32_16x16x32_bf16 v[196:199], v[172:175], a[244:247], v[196:199]
    s_add_u32 s32, s32, 4608
    v_cmp_ne_u32 vcc, 0, v1
    s_and_b32 vcc_hi, vcc_hi, 0xff
    s_cmp_lg_u64 vcc, 0
    s_cbranch_scc1 L_spin_ag
L_back_ag:
    v_mfma_f32_16x16x32_bf16 v[192:195], v[172:175], a[240:243], v[192:195]
    buffer_load_dwordx4 a[28:31], v32, s[28:31], s32 offen offset:0 sc1
    v_fma_f32 v208, v212, v38, v208
    v_mfma_f32_16x16x32_bf16 v[188:191], v[168:171], a[244:247], v[188:191]
    buffer_load_dwordx4 a[24:27], v32, s[28:31], s32 offen offset:1024 sc1
    v_fma_f32 v209, v213, v38, v209
    v_mfma_f32_16x16x32_bf16 v[184:187], v[168:171], a[240:243], v[184:187]
    s_waitcnt lgkmcnt(0)
    v_fma_f32 v208, -v213, v39, v208
    v_fmac_f32 v209, v212, v39
    v_mfma_f32_16x16x32_bf16 v[196:199], v[164:167], a[236:239], v[196:199]
    ds_read_b128 v[180:183], v10 offset:8192
    v_fma_f32 v204, v208, v38, v204
    v_mfma_f32_16x16x32_bf16 v[192:195], v[164:167], a[232:235], v[192:195]
    ds_read_b128 v[176:179], v10 offset:9216
    v_fma_f32 v205, v209, v38, v205
    v_mfma_f32_16x16x32_bf16 v[188:191], v[160:163], a[236:239], v[188:191]
    ds_read_b128 v[172:175], v10 offset:10240
    v_fma_f32 v204, -v209, v39, v204
    v_mfma_f32_16x16x32_bf16 v[184:187], v[160:163], a[232:235], v[184:187]
    ds_read_b128 v[168:171], v10 offset:11264
    v_fmac_f32 v205, v208, v39
    v_mfma_f32_16x16x32_bf16 v[196:199], v[156:159], a[228:231], v[196:199]
    buffer_load_dwordx4 a[20:23], v32, s[28:31], s32 offen offset:2048 sc1
    v_fma_f32 v200, v204, v38, v200
    v_mfma_f32_16x16x32_bf16 v[192:195], v[156:159], a[224:227], v[192:195]
    v_fma_f32 v201, v205, v38, v201
    v_fma_f32 v200, -v205, v39, v200
    v_mfma_f32_16x16x32_bf16 v[188:191], v[152:155], a[228:231], v[188:191]
    buffer_load_dwordx4 a[16:19], v32, s[28:31], s32 offen offset:3072 sc1
    v_fmac_f32 v201, v204, v39
    v_mfma_f32_16x16x32_bf16 v[184:187], v[152:155], a[224:227], v[184:187]
    v_mul_f32 v212, v200, v42
    v_mul_f32 v213, v201, v42
    v_fma_f32 v212, -v201, v43, v212
    v_fmac_f32 v213, v200, v43
    ds_write_b64 v46, v[212:213] offset:2304
    s_waitcnt lgkmcnt(0)
    s_barrier
    v_mfma_f32_16x16x32_bf16 v[196:199], v[180:183], a[220:223], v[196:199]
    ds_read_b128 v[164:167], v10 offset:12288
    v_add_u32 v47, 2304, v47
    v_mfma_f32_16x16x32_bf16 v[192:195], v[180:183], a[216:219], v[192:195]
    ds_read_b128 v[160:163], v10 offset:13312
    v_mfma_f32_16x16x32_bf16 v[188:191], v[176:179], a[220:223], v[188:191]
    ds_read_b128 v[156:159], v10 offset:14336
    v_mfma_f32_16x16x32_bf16 v[184:187], v[176:179], a[216:219], v[184:187]
    ds_read_b128 v[152:155], v10 offset:15360
    v_mfma_f32_16x16x32_bf16 v[196:199], v[172:175], a[212:215], v[196:199]
    buffer_load_dwordx4 a[12:15], v33, s[28:31], s32 offen sc1
    v_mfma_f32_16x16x32_bf16 v[192:195], v[172:175], a[208:211], v[192:195]
    ds_read2_b64 v[208:211], v47 offset0:0 offset1:1
    v_mfma_f32_16x16x32_bf16 v[188:191], v[168:171], a[212:215], v[188:191]
    s_add_u32 s32, s32, 4608
    ds_read2_b64 v[204:207], v47 offset0:2 offset1:3
    v_mfma_f32_16x16x32_bf16 v[184:187], v[168:171], a[208:211], v[184:187]
    s_waitcnt lgkmcnt(2)
    v_mfma_f32_16x16x32_bf16 v[196:199], v[164:167], a[204:207], v[196:199]
    ds_read_b128 v[180:183], v15 offset:0
    v_mfma_f32_16x16x32_bf16 v[192:195], v[164:167], a[200:203], v[192:195]
    ds_read_b128 v[176:179], v15 offset:1024
    v_mfma_f32_16x16x32_bf16 v[188:191], v[160:163], a[204:207], v[188:191]
    ds_read_b128 v[172:175], v15 offset:2048
    s_waitcnt lgkmcnt(3)
    v_mfma_f32_16x16x32_bf16 v[184:187], v[160:163], a[200:203], v[184:187]
    ds_read_b128 v[168:171], v15 offset:3072
    v_add_f32 v208, v208, v210
    v_mfma_f32_16x16x32_bf16 v[196:199], v[156:159], a[196:199], v[196:199]
    buffer_load_dwordx4 a[8:11], v32, s[28:31], s32 offen offset:0 sc1
    v_add_f32 v204, v204, v206
    v_mfma_f32_16x16x32_bf16 v[192:195], v[156:159], a[192:195], v[192:195]
    buffer_load_dwordx4 a[4:7], v32, s[28:31], s32 offen offset:1024 sc1
    v_add_f32 v209, v209, v211
    v_mfma_f32_16x16x32_bf16 v[188:191], v[152:155], a[196:199], v[188:191]
    v_add_f32 v205, v205, v207
    v_add_f32 v208, v208, v204
    v_mfma_f32_16x16x32_bf16 v[184:187], v[152:155], a[192:195], v[184:187]
    s_waitcnt lgkmcnt(0)
    v_add_f32 v209, v209, v205
    v_fma_f32 v148, v208, v40, v24
    v_mfma_f32_16x16x32_bf16 v[196:199], v[180:183], a[188:191], v[196:199]
    ds_read_b128 v[164:167], v15 offset:4096
    v_fma_f32 v149, v209, v40, v25
    v_mfma_f32_16x16x32_bf16 v[192:195], v[180:183], a[184:187], v[192:195]
    ds_read_b128 v[160:163], v15 offset:5120
    v_fma_f32 v148, -v209, v41, v148
    v_mfma_f32_16x16x32_bf16 v[188:191], v[176:179], a[188:191], v[188:191]
    ds_read_b128 v[156:159], v15 offset:6144
    v_fmac_f32 v149, v208, v41
    v_mfma_f32_16x16x32_bf16 v[184:187], v[176:179], a[184:187], v[184:187]
    ds_read_b128 v[152:155], v15 offset:7168
    v_mfma_f32_16x16x32_bf16 v[196:199], v[172:175], a[180:183], v[196:199]
    buffer_load_dwordx4 a[0:3], v32, s[28:31], s32 offen offset:2048 sc1
    v_mfma_f32_16x16x32_bf16 v[192:195], v[172:175], a[176:179], v[192:195]
    ds_write_b64 v44, v[148:149]
    v_mfma_f32_16x16x32_bf16 v[188:191], v[168:171], a[180:183], v[188:191]
    s_add_u32 m0, s48, -3072
    v_fma_f32 v150, v148, v34, v108
    v_fma_f32 v151, v149, v34, v109
    v_mfma_f32_16x16x32_bf16 v[184:187], v[168:171], a[176:179], v[184:187]
    s_waitcnt lgkmcnt(1)
    v_fma_f32 v150, -v149, v35, v150
    v_fmac_f32 v151, v148, v35
    v_mfma_f32_16x16x32_bf16 v[196:199], v[164:167], a[172:175], v[196:199]
    ds_read_b128 v[180:183], v15 offset:8192
    v_mfma_f32_16x16x32_bf16 v[192:195], v[164:167], a[168:171], v[192:195]
    ds_read_b128 v[176:179], v15 offset:9216
    v_mfma_f32_16x16x32_bf16 v[188:191], v[160:163], a[172:175], v[188:191]
    ds_read_b128 v[172:175], v15 offset:10240
    v_mfma_f32_16x16x32_bf16 v[184:187], v[160:163], a[168:171], v[184:187]
    ds_read_b128 v[168:171], v15 offset:11264
    v_mfma_f32_16x16x32_bf16 v[196:199], v[156:159], a[164:167], v[196:199]
    buffer_load_dwordx4 v32, s[28:31], s32 offen offset:3072 sc1 lds
    v_mfma_f32_16x16x32_bf16 v[192:195], v[156:159], a[160:163], v[192:195]
    s_add_u32 m0, s48, 1024
    ds_write_b64 v44, v[150:151] offset:320
    v_mfma_f32_16x16x32_bf16 v[188:191], v[152:155], a[164:167], v[188:191]
    buffer_load_dwordx4 v33, s[28:31], s32 offen sc1 lds
    v_fma_f32 v144, v150, v34, v110
    v_mfma_f32_16x16x32_bf16 v[184:187], v[152:155], a[160:163], v[184:187]
    s_waitcnt lgkmcnt(1)
    v_fma_f32 v145, v151, v34, v111
    v_fma_f32 v144, -v151, v35, v144
    v_mfma_f32_16x16x32_bf16 v[196:199], v[180:183], a[156:159], v[196:199]
    ds_read_b128 v[164:167], v15 offset:12288
    v_fmac_f32 v145, v150, v35
    v_mfma_f32_16x16x32_bf16 v[192:195], v[180:183], a[152:155], v[192:195]
    ds_read_b128 v[160:163], v15 offset:13312
    v_mfma_f32_16x16x32_bf16 v[188:191], v[176:179], a[156:159], v[188:191]
    ds_read_b128 v[156:159], v15 offset:14336
    v_mfma_f32_16x16x32_bf16 v[184:187], v[176:179], a[152:155], v[184:187]
    ds_read_b128 v[152:155], v15 offset:15360
    v_mfma_f32_16x16x32_bf16 v[196:199], v[172:175], a[148:151], v[196:199]
    s_add_u32 s32, s32, 4608
    s_add_u32 m0, s48, 2048
    v_mfma_f32_16x16x32_bf16 v[192:195], v[172:175], a[144:147], v[192:195]
    buffer_load_dwordx4 v32, s[28:31], s32 offen offset:0 sc1 lds
    v_mfma_f32_16x16x32_bf16 v[188:191], v[168:171], a[148:151], v[188:191]
    buffer_load_dwordx4 v32, s[28:31], s32 offen offset:1024 sc1 lds
    v_mfma_f32_16x16x32_bf16 v[184:187], v[168:171], a[144:147], v[184:187]
    s_waitcnt lgkmcnt(0)
    ds_write_b64 v44, v[144:145] offset:640
    v_mfma_f32_16x16x32_bf16 v[196:199], v[164:167], a[140:143], v[196:199]
    ds_read_b128 v[180:183], v15 offset:16384
    v_fma_f32 v146, v144, v34, v104
    v_mfma_f32_16x16x32_bf16 v[192:195], v[164:167], a[136:139], v[192:195]
    ds_read_b128 v[176:179], v15 offset:17408
    v_fma_f32 v147, v145, v34, v105
    v_mfma_f32_16x16x32_bf16 v[188:191], v[160:163], a[140:143], v[188:191]
    ds_read_b128 v[172:175], v15 offset:18432
    v_fma_f32 v146, -v145, v35, v146
    v_mfma_f32_16x16x32_bf16 v[184:187], v[160:163], a[136:139], v[184:187]
    ds_read_b128 v[168:171], v15 offset:19456
    v_fmac_f32 v147, v144, v35
    v_mfma_f32_16x16x32_bf16 v[196:199], v[156:159], a[132:135], v[196:199]
    buffer_load_dwordx4 v32, s[28:31], s32 offen offset:2048 sc1 lds
    v_mfma_f32_16x16x32_bf16 v[192:195], v[156:159], a[128:131], v[192:195]
    ds_write_b64 v44, v[146:147] offset:960
    v_mfma_f32_16x16x32_bf16 v[188:191], v[152:155], a[132:135], v[188:191]
    buffer_load_dwordx4 v32, s[28:31], s32 offen offset:3072 sc1 lds
    v_mfma_f32_16x16x32_bf16 v[184:187], v[152:155], a[128:131], v[184:187]
    s_waitcnt lgkmcnt(1)
    ds_read2_b32 v[140:141], v45 offset0:0 offset1:16
    v_mfma_f32_16x16x32_bf16 v[196:199], v[180:183], a[124:127], v[196:199]
    ds_read2_b32 v[142:143], v45 offset0:32 offset1:48
    v_mfma_f32_16x16x32_bf16 v[192:195], v[180:183], a[120:123], v[192:195]
    ds_read_b32 v136, v45 offset:256
    v_mfma_f32_16x16x32_bf16 v[188:191], v[176:179], a[124:127], v[188:191]
    s_add_u32 m0, s48, 6144
    v_mfma_f32_16x16x32_bf16 v[184:187], v[176:179], a[120:123], v[184:187]
    buffer_load_dwordx4 v33, s[28:31], s32 offen sc1 lds
    v_mfma_f32_16x16x32_bf16 v[196:199], v[172:175], a[116:119], v[196:199]
    v_mfma_f32_16x16x32_bf16 v[192:195], v[172:175], a[112:115], v[192:195]
    s_waitcnt lgkmcnt(0)
    v_fmac_f32 v252, v128, v140
    v_fmac_f32 v248, v130, v141
    v_mfma_f32_16x16x32_bf16 v[188:191], v[168:171], a[116:119], v[188:191]
    s_add_u32 s32, s32, 4608
    s_add_u32 m0, s48, 7168
    v_fmac_f32 v244, v124, v142
    v_mfma_f32_16x16x32_bf16 v[184:187], v[168:171], a[112:115], v[184:187]
    buffer_load_dwordx4 v32, s[28:31], s32 offen offset:0 sc1 lds
    buffer_load_dwordx4 v32, s[28:31], s32 offen offset:1024 sc1 lds
    buffer_load_dwordx4 v32, s[28:31], s32 offen offset:2048 sc1 lds
    buffer_load_dwordx4 v32, s[28:31], s32 offen offset:3072 sc1 lds
    s_add_u32 m0, s48, 11264
    s_nop 0
    buffer_load_dwordx4 v33, s[28:31], s32 offen sc1 lds
    s_add_u32 s32, s32, 4608
    s_add_u32 m0, s48, 12288
    s_nop 0
    buffer_load_dwordx4 v32, s[28:31], s32 offen offset:0 sc1 lds
    buffer_load_dwordx4 v32, s[28:31], s32 offen offset:1024 sc1 lds
    buffer_load_dwordx4 v32, s[28:31], s32 offen offset:2048 sc1 lds
    buffer_load_dwordx4 v32, s[28:31], s32 offen offset:3072 sc1 lds
    v_fmac_f32 v240, v126, v143
    v_fmac_f32 v236, v120, v136
    v_fmac_f32_dpp v252, v140, v129 row_ror:8 row_mask:0xf bank_mask:0xf
    v_fmac_f32_dpp v248, v141, v131 row_ror:8 row_mask:0xf bank_mask:0xf
    v_fmac_f32_dpp v244, v142, v125 row_ror:8 row_mask:0xf bank_mask:0xf
    v_fmac_f32_dpp v240, v143, v127 row_ror:8 row_mask:0xf bank_mask:0xf
    v_fmac_f32_dpp v236, v136, v121 row_ror:8 row_mask:0xf bank_mask:0xf
    v_fmac_f32 v253, v128, v252
    v_fmac_f32 v249, v130, v248
    v_fmac_f32 v245, v124, v244
    v_fmac_f32 v241, v126, v240
    v_fmac_f32 v237, v120, v236
    v_fmac_f32_dpp v253, v252, v129 row_ror:8 row_mask:0xf bank_mask:0xf
    v_fmac_f32_dpp v249, v248, v131 row_ror:8 row_mask:0xf bank_mask:0xf
    v_fmac_f32_dpp v245, v244, v125 row_ror:8 row_mask:0xf bank_mask:0xf
    v_fmac_f32_dpp v241, v240, v127 row_ror:8 row_mask:0xf bank_mask:0xf
    v_fmac_f32_dpp v237, v236, v121 row_ror:8 row_mask:0xf bank_mask:0xf
    v_fmac_f32 v254, v128, v253
    v_fmac_f32 v250, v130, v249
    v_fmac_f32 v246, v124, v245
    v_fmac_f32 v242, v126, v241
    v_fmac_f32 v238, v120, v237
    v_fmac_f32_dpp v254, v253, v129 row_ror:8 row_mask:0xf bank_mask:0xf
    v_fmac_f32_dpp v250, v249, v131 row_ror:8 row_mask:0xf bank_mask:0xf
    v_fmac_f32_dpp v246, v245, v125 row_ror:8 row_mask:0xf bank_mask:0xf
    v_fmac_f32_dpp v242, v241, v127 row_ror:8 row_mask:0xf bank_mask:0xf
    v_fmac_f32_dpp v238, v237, v121 row_ror:8 row_mask:0xf bank_mask:0xf
    v_fmac_f32 v255, v128, v254
    v_fmac_f32 v251, v130, v250
    v_fmac_f32 v247, v124, v246
    v_fmac_f32 v243, v126, v242
    v_fmac_f32 v239, v120, v238
    v_fmac_f32_dpp v255, v254, v129 row_ror:8 row_mask:0xf bank_mask:0xf
    v_fmac_f32_dpp v251, v250, v131 row_ror:8 row_mask:0xf bank_mask:0xf
    v_fmac_f32_dpp v247, v246, v125 row_ror:8 row_mask:0xf bank_mask:0xf
    v_fmac_f32_dpp v243, v242, v127 row_ror:8 row_mask:0xf bank_mask:0xf
    v_fmac_f32_dpp v239, v238, v121 row_ror:8 row_mask:0xf bank_mask:0xf
    v_fmac_f32 v232, v128, v255
    v_fmac_f32 v228, v130, v251
    v_fmac_f32 v224, v124, v247
    v_fmac_f32 v220, v126, v243
    v_fmac_f32 v216, v120, v239
    v_fmac_f32_dpp v232, v255, v129 row_ror:8 row_mask:0xf bank_mask:0xf
    v_fmac_f32_dpp v228, v251, v131 row_ror:8 row_mask:0xf bank_mask:0xf
    v_fmac_f32_dpp v224, v247, v125 row_ror:8 row_mask:0xf bank_mask:0xf
    v_fmac_f32_dpp v220, v243, v127 row_ror:8 row_mask:0xf bank_mask:0xf
    v_fmac_f32_dpp v216, v239, v121 row_ror:8 row_mask:0xf bank_mask:0xf
    v_fmac_f32 v233, v128, v232
    v_fmac_f32 v229, v130, v228
    v_fmac_f32 v225, v124, v224
    v_fmac_f32 v221, v126, v220
    v_fmac_f32 v217, v120, v216
    v_fmac_f32_dpp v233, v232, v129 row_ror:8 row_mask:0xf bank_mask:0xf
    v_fmac_f32_dpp v229, v228, v131 row_ror:8 row_mask:0xf bank_mask:0xf
    v_fmac_f32_dpp v225, v224, v125 row_ror:8 row_mask:0xf bank_mask:0xf
    v_fmac_f32_dpp v221, v220, v127 row_ror:8 row_mask:0xf bank_mask:0xf
    v_fmac_f32_dpp v217, v216, v121 row_ror:8 row_mask:0xf bank_mask:0xf
    v_fmac_f32 v234, v128, v233
    v_fmac_f32 v230, v130, v229
    v_fmac_f32 v226, v124, v225
    v_fmac_f32 v222, v126, v221
    v_fmac_f32 v218, v120, v217
    v_fmac_f32_dpp v234, v233, v129 row_ror:8 row_mask:0xf bank_mask:0xf
    v_fmac_f32_dpp v230, v229, v131 row_ror:8 row_mask:0xf bank_mask:0xf
    v_fmac_f32_dpp v226, v225, v125 row_ror:8 row_mask:0xf bank_mask:0xf
    v_fmac_f32_dpp v222, v221, v127 row_ror:8 row_mask:0xf bank_mask:0xf
    v_fmac_f32_dpp v218, v217, v121 row_ror:8 row_mask:0xf bank_mask:0xf
    v_fmac_f32 v235, v128, v234
    v_fmac_f32 v231, v130, v230
    v_fmac_f32 v227, v124, v226
    v_fmac_f32 v223, v126, v222
    v_fmac_f32 v219, v120, v218
    v_fmac_f32_dpp v235, v234, v129 row_ror:8 row_mask:0xf bank_mask:0xf
    v_fmac_f32_dpp v231, v230, v131 row_ror:8 row_mask:0xf bank_mask:0xf
    v_fmac_f32_dpp v227, v226, v125 row_ror:8 row_mask:0xf bank_mask:0xf
    v_fmac_f32_dpp v223, v222, v127 row_ror:8 row_mask:0xf bank_mask:0xf
    v_fmac_f32_dpp v219, v218, v121 row_ror:8 row_mask:0xf bank_mask:0xf
    v_cvt_pk_bf16_f32 v132, v252, v253
    v_cvt_pk_bf16_f32 v133, v254, v255
    v_cvt_pk_bf16_f32 v134, v232, v233
    v_cvt_pk_bf16_f32 v135, v234, v235
    ds_write_b128 v70, v[132:135] offset:0
    v_cvt_pk_bf16_f32 v116, v248, v249
    v_cvt_pk_bf16_f32 v117, v250, v251
    v_cvt_pk_bf16_f32 v118, v228, v229
    v_cvt_pk_bf16_f32 v119, v230, v231
    ds_write_b128 v70, v[116:119] offset:1280
    v_cvt_pk_bf16_f32 v112, v244, v245
    v_cvt_pk_bf16_f32 v113, v246, v247
    v_cvt_pk_bf16_f32 v114, v224, v225
    v_cvt_pk_bf16_f32 v115, v226, v227
    ds_write_b128 v70, v[112:115] offset:2560
    v_cvt_pk_bf16_f32 v92, v240, v241
    v_cvt_pk_bf16_f32 v93, v242, v243
    v_cvt_pk_bf16_f32 v94, v220, v221
    v_cvt_pk_bf16_f32 v95, v222, v223
    ds_write_b128 v70, v[92:95] offset:3840
    v_cvt_pk_bf16_f32 v88, v236, v237
    v_cvt_pk_bf16_f32 v89, v238, v239
    v_cvt_pk_bf16_f32 v90, v216, v217
    v_cvt_pk_bf16_f32 v91, v218, v219
    ds_write_b128 v70, v[88:91] offset:5120
    ds_read_b64_tr_b16 v[132:133], v71 offset:0
    ds_read_b64_tr_b16 v[134:135], v71 offset:320
    ds_read_b64_tr_b16 v[116:117], v71 offset:640
    ds_read_b64_tr_b16 v[118:119], v71 offset:960
    ds_read_b64_tr_b16 v[112:113], v71 offset:8
    ds_read_b64_tr_b16 v[114:115], v71 offset:328
    ds_read_b64_tr_b16 v[92:93], v71 offset:648
    ds_read_b64_tr_b16 v[94:95], v71 offset:968
    ds_read_b64_tr_b16 v[88:89], v75 offset:5120
    ds_read_b64_tr_b16 v[90:91], v75 offset:5760
    buffer_load_dwordx4 v[252:255], v68, s[28:31], 0 offen offset:0 sc1
    buffer_load_dwordx4 v[248:251], v68, s[28:31], 0 offen offset:1024 sc1
    buffer_load_dwordx4 v[244:247], v68, s[28:31], 0 offen offset:2048 sc1
    buffer_load_dwordx4 v[240:243], v68, s[28:31], 0 offen offset:3072 sc1
    buffer_load_dwordx4 v[236:239], v68, s[28:31], s18 offen offset:0 sc1
    buffer_load_dwordx4 v[232:235], v68, s[28:31], s18 offen offset:1024 sc1
    v_permlane32_swap_b32 v196, v192
    v_permlane32_swap_b32 v197, v193
    v_permlane32_swap_b32 v198, v194
    v_permlane32_swap_b32 v199, v195
    v_permlane32_swap_b32 v188, v184
    v_permlane32_swap_b32 v189, v185
    v_permlane32_swap_b32 v190, v186
    v_permlane32_swap_b32 v191, v187
    v_mul_f32 v186, 0xbfb8aa3b, v186
    v_exp_f32 v186, v186
    v_mov_b64 v[158:159], 0
    v_add_f32 v186, 1.0, v186
    buffer_load_dwordx4 v[228:231], v68, s[28:31], s18 offen offset:2048 sc1
    v_rcp_f32 v186, v186
    s_nop 0
    ds_write_b32 v63, v186
    ds_read_b32 v20, v59 offset:0
    ds_read_b32 v21, v59 offset:16
    v_max3_f32 v24, v16, v17, v18
    v_min3_f32 v25, v16, v17, v18
    v_max3_f32 v24, v24, v19, v196
    v_min3_f32 v25, v25, v19, v196
    v_max3_f32 v24, v24, v197, v198
    v_min3_f32 v25, v25, v197, v198
    v_max3_f32 v24, v24, v199, v192
    buffer_load_dwordx4 v[224:227], v68, s[28:31], s18 offen offset:3072 sc1
    v_min3_f32 v25, v25, v199, v192
    v_max3_f32 v24, v24, v193, v194
    v_min3_f32 v25, v25, v193, v194
    v_max3_f32 v24, v24, v195, v188
    v_min3_f32 v25, v25, v195, v188
    v_max3_f32 v24, v24, v189, v190
    v_min3_f32 v25, v25, v189, v190
    v_max3_f32 v24, v24, v191, v184
    v_min3_f32 v25, v25, v191, v184
    v_max_f32 v24, v24, v185
    v_min_f32 v25, v25, v185
    v_pk_mul_f32 v[24:25], v[24:25], s[42:43]
    v_pk_fma_f32 v[124:125], v[16:17], s[42:43], v[24:25] op_sel:[0,0,1] op_sel_hi:[1,1,1] neg_lo:[1,0,0] neg_hi:[1,0,0]
    v_pk_fma_f32 v[16:17], v[16:17], s[42:43], v[24:25] op_sel:[0,0,0] op_sel_hi:[1,1,0] neg_lo:[0,0,1] neg_hi:[0,0,1]
    v_pk_fma_f32 v[126:127], v[18:19], s[42:43], v[24:25] op_sel:[0,0,1] op_sel_hi:[1,1,1] neg_lo:[1,0,0] neg_hi:[1,0,0]
    v_pk_fma_f32 v[18:19], v[18:19], s[42:43], v[24:25] op_sel:[0,0,0] op_sel_hi:[1,1,0] neg_lo:[0,0,1] neg_hi:[0,0,1]
    buffer_load_dwordx4 v[220:223], v68, s[28:31], s20 offen offset:0 sc1
    v_pk_fma_f32 v[120:121], v[196:197], s[42:43], v[24:25] op_sel:[0,0,1] op_sel_hi:[1,1,1] neg_lo:[1,0,0] neg_hi:[1,0,0]
    v_pk_fma_f32 v[196:197], v[196:197], s[42:43], v[24:25] op_sel:[0,0,0] op_sel_hi:[1,1,0] neg_lo:[0,0,1] neg_hi:[0,0,1]
    v_pk_fma_f32 v[122:123], v[198:199], s[42:43], v[24:25] op_sel:[0,0,1] op_sel_hi:[1,1,1] neg_lo:[1,0,0] neg_hi:[1,0,0]
    v_pk_fma_f32 v[198:199], v[198:199], s[42:43], v[24:25] op_sel:[0,0,0] op_sel_hi:[1,1,0] neg_lo:[0,0,1] neg_hi:[0,0,1]
    v_pk_fma_f32 v[108:109], v[192:193], s[42:43], v[24:25] op_sel:[0,0,1] op_sel_hi:[1,1,1] neg_lo:[1,0,0] neg_hi:[1,0,0]
    v_pk_fma_f32 v[192:193], v[192:193], s[42:43], v[24:25] op_sel:[0,0,0] op_sel_hi:[1,1,0] neg_lo:[0,0,1] neg_hi:[0,0,1]
    v_pk_fma_f32 v[110:111], v[194:195], s[42:43], v[24:25] op_sel:[0,0,1] op_sel_hi:[1,1,1] neg_lo:[1,0,0] neg_hi:[1,0,0]
    v_pk_fma_f32 v[194:195], v[194:195], s[42:43], v[24:25] op_sel:[0,0,0] op_sel_hi:[1,1,0] neg_lo:[0,0,1] neg_hi:[0,0,1]
    v_pk_fma_f32 v[104:105], v[188:189], s[42:43], v[24:25] op_sel:[0,0,1] op_sel_hi:[1,1,1] neg_lo:[1,0,0] neg_hi:[1,0,0]
    v_pk_fma_f32 v[188:189], v[188:189], s[42:43], v[24:25] op_sel:[0,0,0] op_sel_hi:[1,1,0] neg_lo:[0,0,1] neg_hi:[0,0,1]
    v_pk_fma_f32 v[106:107], v[190:191], s[42:43], v[24:25] op_sel:[0,0,1] op_sel_hi:[1,1,1] neg_lo:[1,0,0] neg_hi:[1,0,0]
    v_pk_fma_f32 v[190:191], v[190:191], s[42:43], v[24:25] op_sel:[0,0,0] op_sel_hi:[1,1,0] neg_lo:[0,0,1] neg_hi:[0,0,1]
    v_pk_fma_f32 v[100:101], v[184:185], s[42:43], v[24:25] op_sel:[0,0,1] op_sel_hi:[1,1,1] neg_lo:[1,0,0] neg_hi:[1,0,0]
    v_pk_fma_f32 v[184:185], v[184:185], s[42:43], v[24:25] op_sel:[0,0,0] op_sel_hi:[1,1,0] neg_lo:[0,0,1] neg_hi:[0,0,1]
    v_exp_f32 v16, v16
    buffer_load_dwordx4 v[216:219], v68, s[28:31], s20 offen offset:1024 sc1
    v_exp_f32 v17, v17
    v_exp_f32 v18, v18
    v_exp_f32 v19, v19
    v_exp_f32 v196, v196
    v_exp_f32 v197, v197
    v_exp_f32 v198, v198
    v_exp_f32 v199, v199
    v_exp_f32 v192, v192
    buffer_load_dwordx4 v[212:215], v68, s[28:31], s20 offen offset:2048 sc1
    v_exp_f32 v193, v193
    v_exp_f32 v194, v194
    v_exp_f32 v195, v195
    v_exp_f32 v188, v188
    v_exp_f32 v189, v189
    v_exp_f32 v190, v190
    v_exp_f32 v191, v191
    v_exp_f32 v184, v184
    buffer_load_dwordx4 v[208:211], v68, s[28:31], s20 offen offset:3072 sc1
    v_exp_f32 v185, v185
    v_exp_f32 v124, v124
    v_exp_f32 v125, v125
    v_exp_f32 v126, v126
    v_exp_f32 v127, v127
    v_exp_f32 v120, v120
    v_exp_f32 v121, v121
    v_exp_f32 v122, v122
    buffer_load_dwordx4 v[204:207], v68, s[28:31], s21 offen offset:0 sc1
    v_exp_f32 v123, v123
    v_exp_f32 v108, v108
    v_exp_f32 v109, v109
    v_exp_f32 v110, v110
    v_exp_f32 v111, v111
    v_exp_f32 v104, v104
    v_exp_f32 v105, v105
    v_exp_f32 v106, v106
    buffer_load_dwordx4 v[200:203], v68, s[28:31], s21 offen offset:1024 sc1
    v_exp_f32 v107, v107
    v_exp_f32 v100, v100
    v_exp_f32 v101, v101
    v_pk_add_f32 v[24:25], v[16:17], v[18:19]
    v_pk_add_f32 v[26:27], v[124:125], v[126:127]
    v_pk_add_f32 v[24:25], v[24:25], v[196:197]
    v_pk_add_f32 v[26:27], v[26:27], v[120:121]
    v_pk_add_f32 v[24:25], v[24:25], v[198:199]
    v_pk_add_f32 v[26:27], v[26:27], v[122:123]
    v_pk_add_f32 v[24:25], v[24:25], v[192:193]
    v_pk_add_f32 v[26:27], v[26:27], v[108:109]
    v_pk_add_f32 v[24:25], v[24:25], v[194:195]
    v_pk_add_f32 v[26:27], v[26:27], v[110:111]
    buffer_load_dwordx4 v[180:183], v68, s[28:31], s21 offen offset:2048 sc1
    v_pk_add_f32 v[24:25], v[24:25], v[188:189]
    v_pk_add_f32 v[26:27], v[26:27], v[104:105]
    v_pk_add_f32 v[24:25], v[24:25], v[190:191]
    v_pk_add_f32 v[26:27], v[26:27], v[106:107]
    v_pk_add_f32 v[24:25], v[24:25], v[184:185]
    v_pk_add_f32 v[26:27], v[26:27], v[100:101]
    v_add_f32 v24, v24, v25
    v_add_f32 v25, v26, v27
    v_rcp_f32 v24, v24
    v_rcp_f32 v25, v25
    s_nop 0
    v_pk_mul_f32 v[16:17], v[16:17], v[24:25] op_sel:[0,0] op_sel_hi:[1,0]
    v_cvt_pk_bf16_f32 v172, v16, v17
    v_pk_mul_f32 v[18:19], v[18:19], v[24:25] op_sel:[0,0] op_sel_hi:[1,0]
    v_cvt_pk_bf16_f32 v173, v18, v19
    buffer_load_dwordx4 v[176:179], v68, s[28:31], s21 offen offset:3072 sc1
    v_pk_mul_f32 v[188:189], v[188:189], v[24:25] op_sel:[0,0] op_sel_hi:[1,0]
    v_cvt_pk_bf16_f32 v174, v188, v189
    v_pk_mul_f32 v[190:191], v[190:191], v[24:25] op_sel:[0,0] op_sel_hi:[1,0]
    v_cvt_pk_bf16_f32 v175, v190, v191
    ds_write_b128 v56, v[172:175] offset:0
    v_pk_mul_f32 v[122:123], v[122:123], v[24:25] op_sel:[0,1] op_sel_hi:[1,1]
    v_cvt_pk_bf16_f32 v168, v122, v123
    v_pk_mul_f32 v[108:109], v[108:109], v[24:25] op_sel:[0,1] op_sel_hi:[1,1]
    v_cvt_pk_bf16_f32 v169, v108, v109
    v_pk_mul_f32 v[196:197], v[196:197], v[24:25] op_sel:[0,0] op_sel_hi:[1,0]
    v_cvt_pk_bf16_f32 v170, v196, v197
    s_waitcnt lgkmcnt(12)
    buffer_store_dwordx4 v[132:135], v76, s[28:31], 0 offen offset:0 sc1
    v_pk_mul_f32 v[198:199], v[198:199], v[24:25] op_sel:[0,0] op_sel_hi:[1,0]
    v_cvt_pk_bf16_f32 v171, v198, v199
    ds_write_b128 v56, v[168:171] offset:16
    v_pk_mul_f32 v[184:185], v[184:185], v[24:25] op_sel:[0,0] op_sel_hi:[1,0]
    v_cvt_pk_bf16_f32 v164, v184, v185
    v_pk_mul_f32 v[124:125], v[124:125], v[24:25] op_sel:[0,1] op_sel_hi:[1,1]
    v_cvt_pk_bf16_f32 v165, v124, v125
    v_pk_mul_f32 v[110:111], v[110:111], v[24:25] op_sel:[0,1] op_sel_hi:[1,1]
    v_cvt_pk_bf16_f32 v166, v110, v111
    v_pk_mul_f32 v[104:105], v[104:105], v[24:25] op_sel:[0,1] op_sel_hi:[1,1]
    v_cvt_pk_bf16_f32 v167, v104, v105
    s_waitcnt lgkmcnt(11)
    buffer_store_dwordx4 v[116:119], v76, s[28:31], 0 offen offset:1024 sc1
    ds_write_b128 v56, v[164:167] offset:32
    v_pk_mul_f32 v[192:193], v[192:193], v[24:25] op_sel:[0,0] op_sel_hi:[1,0]
    v_cvt_pk_bf16_f32 v160, v192, v193
    v_pk_mul_f32 v[194:195], v[194:195], v[24:25] op_sel:[0,0] op_sel_hi:[1,0]
    v_cvt_pk_bf16_f32 v161, v194, v195
    v_pk_mul_f32 v[126:127], v[126:127], v[24:25] op_sel:[0,1] op_sel_hi:[1,1]
    v_cvt_pk_bf16_f32 v162, v126, v127
    v_pk_mul_f32 v[120:121], v[120:121], v[24:25] op_sel:[0,1] op_sel_hi:[1,1]
    v_cvt_pk_bf16_f32 v163, v120, v121
    ds_write_b128 v56, v[160:163] offset:48
    s_waitcnt lgkmcnt(11)
    buffer_store_dwordx4 v[112:115], v76, s[28:31], s41 offen offset:0 sc1
    v_pk_mul_f32 v[106:107], v[106:107], v[24:25] op_sel:[0,1] op_sel_hi:[1,1]
    v_cvt_pk_bf16_f32 v156, v106, v107
    v_pk_mul_f32 v[100:101], v[100:101], v[24:25] op_sel:[0,1] op_sel_hi:[1,1]
    v_cvt_pk_bf16_f32 v157, v100, v101
    ds_write_b128 v56, v[156:159] offset:64
    ds_read_b128 v[196:199], v57 offset:0
    s_waitcnt lgkmcnt(11)
    buffer_store_dwordx4 v[92:95], v76, s[28:31], s41 offen offset:1024 sc1
    ds_read_b128 v[192:195], v57 offset:64
    ds_read_b128 v[188:191], v58 offset:128
    ds_read_b128 v[184:187], v57 offset:2816
    ds_read_b128 v[172:175], v57 offset:2880
    ds_read_b128 v[168:171], v58 offset:2944
    s_waitcnt lgkmcnt(12)
    v_sub_f32 v20, 1.0, v20
    s_waitcnt lgkmcnt(11)
    v_sub_f32 v21, 1.0, v21
    buffer_load_dwordx4 v[128:131], v33, s[28:31], s32 offen sc1
    s_lshr_b32 s53, s61, 1
    s_lshl_b32 s52, s61, 12
    buffer_store_dwordx4 v[88:91], v77, s[28:31], 0 offen offset:2048 sc1
    s_mul_i32 s32, s61, 18432
    s_add_u32 s32, s32, 165888
    s_mul_i32 s69, s53, 4608
    s_add_u32 s69, s69, 239616
    s_lshl1_add_u32 s56, s3, s86
    s_lshl1_add_u32 s56, s56, s33
    s_mul_i32 s64, s61, 9216
    s_add_u32 s64, s64, 4194304
    s_mul_i32 s63, s56, 73728
    s_add_u32 s63, s63, s64
    v_add_u32 v15, s63, v10
    v_add_u32 v16, s41, v15
    s_xor_b32 s63, s56, 1
    s_mul_i32 s63, s63, 73728
    s_add_u32 s63, s63, s64
    v_add_u32 v17, s63, v10
    v_add_u32 v18, s41, v17
    buffer_load_dwordx4 a[252:255], v32, s[28:31], s32 offen offset:0 sc1
    buffer_load_dwordx4 a[248:251], v32, s[28:31], s32 offen offset:1024 sc1
    buffer_load_dwordx4 a[244:247], v32, s[28:31], s32 offen offset:2048 sc1
    buffer_load_dwordx4 a[240:243], v32, s[28:31], s32 offen offset:3072 sc1
    s_movk_i32 s57, 0x3f80
    s_mov_b32 s58, 0x3f800000
L_redo_kv:
    s_waitcnt vmcnt(25)
    v_lshlrev_b32 v164, 16, v252
    v_and_b32 v165, s17, v252
    v_lshlrev_b32 v166, 16, v253
    v_and_b32 v167, s17, v253
    v_lshlrev_b32 v160, 16, v254
    v_and_b32 v161, s17, v254
    v_xor_b32 v1, v255, v14
    s_waitcnt vmcnt(24)
    v_dot2c_f32_bf16 v164, s57, v248
    v_dot2c_f32_bf16 v165, s58, v248
    v_dot2c_f32_bf16 v166, s57, v249
    v_dot2c_f32_bf16 v167, s58, v249
    v_dot2c_f32_bf16 v160, s57, v250
    v_dot2c_f32_bf16 v161, s58, v250
    v_bitop3_b32 v1, v1, v251, v14 bitop3:0xf6
    s_waitcnt vmcnt(23)
    v_dot2c_f32_bf16 v164, s57, v244
    v_dot2c_f32_bf16 v165, s58, v244
    v_dot2c_f32_bf16 v166, s57, v245
    v_dot2c_f32_bf16 v167, s58, v245
    v_dot2c_f32_bf16 v160, s57, v246
    v_dot2c_f32_bf16 v161, s58, v246
    v_bitop3_b32 v1, v1, v247, v14 bitop3:0xf6
    s_waitcnt vmcnt(22)
    v_dot2c_f32_bf16 v164, s57, v240
    v_dot2c_f32_bf16 v165, s58, v240
    v_dot2c_f32_bf16 v166, s57, v241
    v_dot2c_f32_bf16 v167, s58, v241
    v_dot2c_f32_bf16 v160, s57, v242
    v_dot2c_f32_bf16 v161, s58, v242
    v_bitop3_b32 v1, v1, v243, v14 bitop3:0xf6
    s_waitcnt vmcnt(21)
    v_dot2c_f32_bf16 v164, s57, v236
    v_dot2c_f32_bf16 v165, s58, v236
    v_dot2c_f32_bf16 v166, s57, v237
    v_dot2c_f32_bf16 v167, s58, v237
    v_dot2c_f32_bf16 v160, s57, v238
    v_dot2c_f32_bf16 v161, s58, v238
    v_bitop3_b32 v1, v1, v239, v14 bitop3:0xf6
    s_waitcnt vmcnt(20)
    v_dot2c_f32_bf16 v164, s57, v232
    v_dot2c_f32_bf16 v165, s58, v232
    v_dot2c_f32_bf16 v166, s57, v233
    v_dot2c_f32_bf16 v167, s58, v233
    v_dot2c_f32_bf16 v160, s57, v234
    v_dot2c_f32_bf16 v161, s58, v234
    v_bitop3_b32 v1, v1, v235, v14 bitop3:0xf6
    s_waitcnt vmcnt(19)
    v_dot2c_f32_bf16 v164, s57, v228
    v_dot2c_f32_bf16 v165, s58, v228
    v_dot2c_f32_bf16 v166, s57, v229
    v_dot2c_f32_bf16 v167, s58, v229
    v_dot2c_f32_bf16 v160, s57, v230
    v_dot2c_f32_bf16 v161, s58, v230
    v_bitop3_b32 v1, v1, v231, v14 bitop3:0xf6
    s_waitcnt vmcnt(18)
    v_dot2c_f32_bf16 v164, s57, v224
    v_dot2c_f32_bf16 v165, s58, v224
    v_dot2c_f32_bf16 v166, s57, v225
    v_dot2c_f32_bf16 v167, s58, v225
    v_dot2c_f32_bf16 v160, s57, v226
    v_dot2c_f32_bf16 v161, s58, v226
    v_bitop3_b32 v1, v1, v227, v14 bitop3:0xf6
    s_waitcnt vmcnt(17)
    v_dot2c_f32_bf16 v164, s57, v220
    v_dot2c_f32_bf16 v165, s58, v220
    v_dot2c_f32_bf16 v166, s57, v221
    v_dot2c_f32_bf16 v167, s58, v221
    v_dot2c_f32_bf16 v160, s57, v222
    v_dot2c_f32_bf16 v161, s58, v222
    v_bitop3_b32 v1, v1, v223, v14 bitop3:0xf6
    s_waitcnt vmcnt(16)
    v_dot2c_f32_bf16 v164, s57, v216
    v_dot2c_f32_bf16 v165, s58, v216
    v_dot2c_f32_bf16 v166, s57, v217
    v_dot2c_f32_bf16 v167, s58, v217
    v_dot2c_f32_bf16 v160, s57, v218
    v_dot2c_f32_bf16 v161, s58, v218
    v_bitop3_b32 v1, v1, v219, v14 bitop3:0xf6
    s_waitcnt vmcnt(15)
    v_dot2c_f32_bf16 v164, s57, v212
    v_dot2c_f32_bf16 v165, s58, v212
    v_dot2c_f32_bf16 v166, s57, v213
    v_dot2c_f32_bf16 v167, s58, v213
    v_dot2c_f32_bf16 v160, s57, v214
    v_dot2c_f32_bf16 v161, s58, v214
    v_bitop3_b32 v1, v1, v215, v14 bitop3:0xf6
    s_waitcnt vmcnt(14)
    v_dot2c_f32_bf16 v164, s57, v208
    v_dot2c_f32_bf16 v165, s58, v208
    v_dot2c_f32_bf16 v166, s57, v209
    v_dot2c_f32_bf16 v167, s58, v209
    v_dot2c_f32_bf16 v160, s57, v210
    v_dot2c_f32_bf16 v161, s58, v210
    v_bitop3_b32 v1, v1, v211, v14 bitop3:0xf6
    s_waitcnt vmcnt(13)
    v_dot2c_f32_bf16 v164, s57, v204
    v_dot2c_f32_bf16 v165, s58, v204
    v_dot2c_f32_bf16 v166, s57, v205
    v_dot2c_f32_bf16 v167, s58, v205
    v_dot2c_f32_bf16 v160, s57, v206
    v_dot2c_f32_bf16 v161, s58, v206
    v_bitop3_b32 v1, v1, v207, v14 bitop3:0xf6
    s_waitcnt vmcnt(12)
    v_dot2c_f32_bf16 v164, s57, v200
    v_dot2c_f32_bf16 v165, s58, v200
    v_dot2c_f32_bf16 v166, s57, v201
    v_dot2c_f32_bf16 v167, s58, v201
    v_dot2c_f32_bf16 v160, s57, v202
    v_dot2c_f32_bf16 v161, s58, v202
    v_bitop3_b32 v1, v1, v203, v14 bitop3:0xf6
    s_waitcnt vmcnt(11)
    v_dot2c_f32_bf16 v164, s57, v180
    v_dot2c_f32_bf16 v165, s58, v180
    v_dot2c_f32_bf16 v166, s57, v181
    v_dot2c_f32_bf16 v167, s58, v181
    v_dot2c_f32_bf16 v160, s57, v182
    v_dot2c_f32_bf16 v161, s58, v182
    v_bitop3_b32 v1, v1, v183, v14 bitop3:0xf6
    s_waitcnt vmcnt(10)
    v_dot2c_f32_bf16 v164, s57, v176
    v_dot2c_f32_bf16 v165, s58, v176
    v_dot2c_f32_bf16 v166, s57, v177
    v_dot2c_f32_bf16 v167, s58, v177
    v_dot2c_f32_bf16 v160, s57, v178
    v_dot2c_f32_bf16 v161, s58, v178
    v_bitop3_b32 v1, v1, v179, v14 bitop3:0xf6
    v_cmp_ne_u32 vcc, 0, v1
    s_nop 0
    s_cbranch_vccnz L_spin_kv
L_back_kv:
    v_cvt_pk_bf16_f32 v164, v164, v165
    v_cvt_pk_bf16_f32 v165, v166, v167
    v_cvt_pk_bf16_f32 v166, v160, v161
    s_mov_b64 exec, s[34:35]
    ds_write2_b32 v69, v164, v165 offset0:0 offset1:1
    ds_write_b32 v69, v166 offset:8
    s_mov_b64 exec, -1
    s_waitcnt lgkmcnt(0)
    s_barrier
    ds_read_b128 v[228:231], v74 offset:0
    ds_read_b128 v[252:255], v72 offset:0
    ds_read_b128 v[240:243], v73 offset:0
    ds_read_b128 v[224:227], v74 offset:64
    ds_read_b128 v[248:251], v72 offset:64
    ds_read_b128 v[236:239], v73 offset:64
    ds_read_b128 v[220:223], v74 offset:128
    ds_read_b128 v[244:247], v72 offset:128
    ds_read_b128 v[232:235], v73 offset:128
    s_waitcnt lgkmcnt(8)
    v_mfma_f32_16x16x32_bf16 v[208:211], v[228:231], v[196:199], 0
    v_mfma_f32_16x16x32_bf16 v[180:183], v[228:231], v[184:187], 0
    s_waitcnt lgkmcnt(7)
    v_mfma_f32_16x16x32_bf16 v[216:219], v[252:255], v[196:199], 0
    v_mfma_f32_16x16x32_bf16 v[204:207], v[252:255], v[184:187], 0
    s_waitcnt lgkmcnt(6)
    v_mfma_f32_16x16x32_bf16 v[212:215], v[240:243], v[196:199], 0
    v_mfma_f32_16x16x32_bf16 v[200:203], v[240:243], v[184:187], 0
    s_waitcnt lgkmcnt(5)
    v_mfma_f32_16x16x32_bf16 v[208:211], v[224:227], v[192:195], v[208:211]
    v_mfma_f32_16x16x32_bf16 v[180:183], v[224:227], v[172:175], v[180:183]
    s_waitcnt lgkmcnt(4)
    v_mfma_f32_16x16x32_bf16 v[216:219], v[248:251], v[192:195], v[216:219]
    v_mfma_f32_16x16x32_bf16 v[204:207], v[248:251], v[172:175], v[204:207]
    s_waitcnt lgkmcnt(3)
    v_mfma_f32_16x16x32_bf16 v[212:215], v[236:239], v[192:195], v[212:215]
    v_mfma_f32_16x16x32_bf16 v[200:203], v[236:239], v[172:175], v[200:203]
    s_waitcnt lgkmcnt(2)
    v_mfma_f32_16x16x32_bf16 v[208:211], v[220:223], v[188:191], v[208:211]
    v_mfma_f32_16x16x32_bf16 v[180:183], v[220:223], v[168:171], v[180:183]
    s_waitcnt lgkmcnt(1)
    v_mfma_f32_16x16x32_bf16 v[216:219], v[244:247], v[188:191], v[216:219]
    v_mfma_f32_16x16x32_bf16 v[204:207], v[244:247], v[168:171], v[204:207]
    s_waitcnt lgkmcnt(0)
    v_mfma_f32_16x16x32_bf16 v[212:215], v[232:235], v[188:191], v[212:215]
    v_mfma_f32_16x16x32_bf16 v[200:203], v[232:235], v[168:171], v[200:203]
    s_nop 0
    v_add_f32 v208, 0x358637bd, v208
    v_add_f32 v209, 0x358637bd, v209
    v_add_f32 v180, 0x358637bd, v180
    v_add_f32 v181, 0x358637bd, v181
    v_rcp_f32 v208, v208
    v_rcp_f32 v209, v209
    v_rcp_f32 v180, v180
    v_rcp_f32 v181, v181
    v_pk_mul_f32 v[208:209], v[208:209], v[20:21] op_sel:[0,0] op_sel_hi:[1,0]
    v_cndmask_b32 v22, v208, v209, s[36:37]
    v_cndmask_b32 v23, v208, v209, s[38:39]
    v_pk_mul_f32 v[216:217], v[216:217], v[22:23] op_sel:[0,0] op_sel_hi:[1,0]
    v_cvt_pk_bf16_f32 v252, v216, v217
    v_pk_mul_f32 v[218:219], v[218:219], v[22:23] op_sel:[0,1] op_sel_hi:[1,1]
    v_cvt_pk_bf16_f32 v253, v218, v219
    v_pk_mul_f32 v[212:213], v[212:213], v[22:23] op_sel:[0,1] op_sel_hi:[1,1]
    v_cvt_pk_bf16_f32 v254, v212, v213
    v_pk_mul_f32 v[214:215], v[214:215], v[22:23] op_sel:[0,1] op_sel_hi:[1,1]
    v_cvt_pk_bf16_f32 v255, v214, v215
    buffer_store_dwordx4 v[252:255], v78, s[28:31], 0 offen sc1
    v_pk_mul_f32 v[210:211], v[210:211], v[208:209] op_sel:[0,1] op_sel_hi:[1,1]
    v_cvt_pk_bf16_f32 v244, v210, v211
    v_pk_mul_f32 v[180:181], v[180:181], v[20:21] op_sel:[0,1] op_sel_hi:[1,1]
    v_cndmask_b32 v22, v180, v181, s[36:37]
    v_cndmask_b32 v23, v180, v181, s[38:39]
    v_pk_mul_f32 v[204:205], v[204:205], v[22:23] op_sel:[0,0] op_sel_hi:[1,0]
    v_cvt_pk_bf16_f32 v248, v204, v205
    v_pk_mul_f32 v[206:207], v[206:207], v[22:23] op_sel:[0,1] op_sel_hi:[1,1]
    v_cvt_pk_bf16_f32 v249, v206, v207
    v_pk_mul_f32 v[200:201], v[200:201], v[22:23] op_sel:[0,1] op_sel_hi:[1,1]
    v_cvt_pk_bf16_f32 v250, v200, v201
    v_pk_mul_f32 v[202:203], v[202:203], v[22:23] op_sel:[0,1] op_sel_hi:[1,1]
    v_cvt_pk_bf16_f32 v251, v202, v203
    buffer_store_dwordx4 v[248:251], v78, s[28:31], s40 offen sc1
    v_pk_mul_f32 v[182:183], v[182:183], v[180:181] op_sel:[0,1] op_sel_hi:[1,1]
    v_cvt_pk_bf16_f32 v245, v182, v183
    v_cndmask_b32 v244, v244, v245, s[38:39]
    buffer_store_dword v244, v79, s[28:31], 0 offen sc1
    s_waitcnt vmcnt(7)
    s_barrier
    buffer_store_dword v14, v66, s[28:31], 0 offen offset:256 sc1
    buffer_load_dwordx4 a[236:239], v33, s[28:31], s32 offen sc1
    v_mul_u32_u24 v4, 3641, v0
    v_lshrrev_b32 v4, 16, v4
    v_mul_u32_u24 v5, 18, v4
    v_sub_u32 v5, v0, v5
    s_mul_i32 s64, s87, 144
    s_add_u32 s32, s32, 4608
    v_lshl_add_u32 v6, v5, 3, s64
    buffer_load_dwordx4 a[232:235], v32, s[28:31], s32 offen offset:0 sc1
    global_load_dwordx2 v[26:27], v6, s[54:55]
    v_mul_u32_u24 v7, 1152, v4
    v_add_u32 v7, v7, v6
    buffer_load_dwordx4 a[228:231], v32, s[28:31], s32 offen offset:1024 sc1
    v_cmp_gt_u32 vcc, 252, v0
    s_nop 1
    v_cndmask_b32_e64 v24, v11, v7, vcc
    v_cmp_gt_u32 vcc, 144, v0
    s_nop 1
    v_cndmask_b32_e64 v25, v11, v7, vcc
    s_lshr_b32 s63, s56, 1
    buffer_load_dwordx4 a[224:227], v32, s[28:31], s32 offen offset:2048 sc1
    s_mul_i32 s73, s63, 73728
    buffer_load_dwordx2 v[240:241], v24, s[4:7], s73 offen
    s_add_u32 s74, s73, 16128
    buffer_load_dwordx2 v[242:243], v24, s[4:7], s74 offen
    buffer_load_dwordx4 a[220:223], v32, s[28:31], s32 offen offset:3072 sc1
    s_add_u32 s75, s73, 32256
    buffer_load_dwordx2 v[236:237], v24, s[4:7], s75 offen
    s_add_u32 s76, s73, 48384
    buffer_load_dwordx4 a[216:219], v33, s[28:31], s32 offen sc1
    buffer_load_dwordx2 v[238:239], v24, s[4:7], s76 offen
    s_add_u32 s77, s73, 64512
    buffer_load_dwordx2 v[232:233], v25, s[4:7], s77 offen
    s_add_u32 s32, s32, 4608
    s_lshl_b32 s73, s73, 1
    buffer_load_dwordx4 a[212:215], v32, s[28:31], s32 offen offset:0 sc1
    s_lshl_b32 s74, s74, 1
    s_lshl_b32 s75, s75, 1
    s_lshl_b32 s76, s76, 1
    s_lshl_b32 s77, s77, 1
    buffer_load_dwordx4 a[208:211], v32, s[28:31], s32 offen offset:1024 sc1
    v_lshlrev_b32 v22, 1, v24
    v_lshlrev_b32 v23, 1, v25
    v_mul_u32_u24 v20, 336, v4
    v_lshl_add_u32 v20, v5, 4, v20
    v_add_u32 v21, 43008, v20
    buffer_load_dwordx4 a[204:207], v32, s[28:31], s32 offen offset:2048 sc1
    s_lshl_b32 s63, s86, 8
    s_add_u32 s63, s63, 154112
    v_lshl_add_u32 v4, v4, 2, s63
    ds_read_b32 v228, v4 offset:0
    buffer_load_dwordx4 a[200:203], v32, s[28:31], s32 offen offset:3072 sc1
    ds_read_b32 v229, v4 offset:56
    ds_read_b32 v230, v4 offset:112
    ds_read_b32 v231, v4 offset:168
    buffer_load_dwordx4 a[196:199], v33, s[28:31], s32 offen sc1
    ds_read_b32 v224, v4 offset:224
    s_lshl_b32 s64, s33, 7
    s_add_u32 s63, s63, s64
    s_add_u32 s32, s32, 4608
    v_lshl_add_u32 v4, v60, 2, s63
    buffer_load_dwordx4 a[192:195], v32, s[28:31], s32 offen offset:0 sc1
    v_xor_b32 v5, 128, v4
    ds_read_b32 v36, v4 offset:0
    ds_read_b32 v37, v4 offset:16
    buffer_load_dwordx4 a[188:191], v32, s[28:31], s32 offen offset:1024 sc1
    ds_read_b32 v38, v5 offset:0
    ds_read_b32 v39, v5 offset:16
    buffer_load_dwordx4 a[184:187], v32, s[28:31], s32 offen offset:2048 sc1
    s_mul_i32 s63, s56, 36864
    s_add_u32 s63, s63, 9437184
    v_add_u32 v19, s63, v10
    v_add_u32 v34, s40, v19
    s_xor_b32 s63, s56, 1
    buffer_load_dwordx4 a[180:183], v32, s[28:31], s32 offen offset:3072 sc1
    s_mul_i32 s63, s63, 36864
    s_add_u32 s63, s63, 9437184
    v_add_u32 v35, s63, v10
    v_add_u32 v40, s40, v35
    s_lshl_b32 s53, s53, 10
    buffer_load_dwordx4 a[176:179], v33, s[28:31], s32 offen sc1
    s_add_u32 s53, s53, 16384
    v_lshlrev_b32 v5, 3, v12
    v_sub_u32 v43, v19, v5
    s_add_u32 s59, s53, 18432
    v_mul_u32_u24 v5, 336, v60
    buffer_load_dwordx4 a[172:175], v32, s[28:31], s69 offen offset:0 sc1
    v_lshl_add_u32 v5, v13, 4, v5
    s_lshl1_add_u32 s63, s61, s33
    s_mul_i32 s64, s63, 10752
    v_add_u32 v41, s64, v5
    s_xor_b32 s63, s63, 1
    buffer_load_dwordx4 a[168:171], v32, s[28:31], s69 offen offset:1024 sc1
    s_mul_i32 s64, s63, 10752
    v_add_u32 v42, s64, v5
    s_waitcnt lgkmcnt(3)
    v_add_f32 v36, v36, v36
    s_waitcnt lgkmcnt(2)
    v_add_f32 v37, v37, v37
    s_waitcnt lgkmcnt(1)
    v_add_f32 v38, v38, v38
    buffer_load_dwordx4 a[164:167], v32, s[28:31], s69 offen offset:2048 sc1
    s_waitcnt lgkmcnt(0)
    v_add_f32 v39, v39, v39
    buffer_load_dwordx4 a[160:163], v32, s[28:31], s69 offen offset:3072 sc1
    buffer_load_dwordx4 a[156:159], v33, s[28:31], s69 offen sc1
    s_waitcnt vmcnt(28)
    s_barrier
    buffer_store_dword v14, v66, s[28:31], 0 offen offset:384 sc1
    buffer_load_dword v80, v49, s[28:31], 0 offen offset:256 sc1
    s_waitcnt vmcnt(0)
    v_cmp_ne_u32 s[50:51], v80, v14
    s_nop 0
    s_cmp_lg_u64 s[50:51], 0
    s_cbranch_scc1 L_spin_fh
L_back_fh:
    buffer_load_dwordx4 v[108:111], v15, s[28:31], 0 offen offset:0 sc1
    buffer_load_dwordx4 v[104:107], v16, s[28:31], 0 offen offset:0 sc1
    buffer_load_dwordx4 v[100:103], v17, s[28:31], 0 offen offset:0 sc1
    buffer_load_dwordx4 v[96:99], v18, s[28:31], 0 offen offset:0 sc1
    buffer_load_dwordx4 v[92:95], v15, s[28:31], 0 offen offset:1024 sc1
    buffer_load_dwordx4 v[88:91], v16, s[28:31], 0 offen offset:1024 sc1
    buffer_load_dwordx4 v[84:87], v17, s[28:31], 0 offen offset:1024 sc1
    buffer_load_dwordx4 v[76:79], v18, s[28:31], 0 offen offset:1024 sc1
    buffer_load_dwordx4 v[72:75], v15, s[28:31], 0 offen offset:2048 sc1
    buffer_load_dwordx4 v[68:71], v16, s[28:31], 0 offen offset:2048 sc1
    buffer_load_dwordx4 v[56:59], v17, s[28:31], 0 offen offset:2048 sc1
    buffer_load_dwordx4 v[52:55], v18, s[28:31], 0 offen offset:2048 sc1
    s_waitcnt vmcnt(11)
    v_mfma_f32_16x16x32_bf16 v[252:255], a[108:111], v[108:111], 0
    v_mfma_f32_16x16x32_bf16 v[248:251], a[104:107], v[108:111], 0
    v_mfma_f32_16x16x32_bf16 v[244:247], a[100:103], v[108:111], 0
    v_mfma_f32_16x16x32_bf16 v[200:203], a[96:99], v[108:111], 0
    v_mfma_f32_16x16x32_bf16 v[196:199], a[92:95], v[108:111], 0
    s_waitcnt vmcnt(10)
    v_mfma_f32_16x16x32_bf16 v[192:195], a[108:111], v[104:107], 0
    buffer_load_dwordx4 v[108:111], v15, s[28:31], 0 offen offset:3072 sc1
    v_mfma_f32_16x16x32_bf16 v[188:191], a[104:107], v[104:107], 0
    v_mfma_f32_16x16x32_bf16 v[184:187], a[100:103], v[104:107], 0
    v_mfma_f32_16x16x32_bf16 v[180:183], a[96:99], v[104:107], 0
    v_mfma_f32_16x16x32_bf16 v[176:179], a[92:95], v[104:107], 0
    s_waitcnt vmcnt(10)
    v_mfma_f32_16x16x32_bf16 v[172:175], a[108:111], v[100:103], 0
    buffer_load_dwordx4 v[104:107], v16, s[28:31], 0 offen offset:3072 sc1
    v_mfma_f32_16x16x32_bf16 v[168:171], a[104:107], v[100:103], 0
    v_mfma_f32_16x16x32_bf16 v[164:167], a[100:103], v[100:103], 0
    v_mfma_f32_16x16x32_bf16 v[160:163], a[96:99], v[100:103], 0
    v_mfma_f32_16x16x32_bf16 v[156:159], a[92:95], v[100:103], 0
    s_waitcnt vmcnt(10)
    v_mfma_f32_16x16x32_bf16 v[132:135], a[108:111], v[96:99], 0
    buffer_load_dwordx4 v[100:103], v17, s[28:31], 0 offen offset:3072 sc1
    v_mfma_f32_16x16x32_bf16 v[124:127], a[104:107], v[96:99], 0
    v_mfma_f32_16x16x32_bf16 v[120:123], a[100:103], v[96:99], 0
    v_mfma_f32_16x16x32_bf16 v[116:119], a[96:99], v[96:99], 0
    v_mfma_f32_16x16x32_bf16 v[112:115], a[92:95], v[96:99], 0
    s_waitcnt vmcnt(10)
    v_mfma_f32_16x16x32_bf16 v[252:255], a[88:91], v[92:95], v[252:255]
    buffer_load_dwordx4 v[96:99], v18, s[28:31], 0 offen offset:3072 sc1
    v_mfma_f32_16x16x32_bf16 v[248:251], a[84:87], v[92:95], v[248:251]
    v_mfma_f32_16x16x32_bf16 v[244:247], a[80:83], v[92:95], v[244:247]
    v_mfma_f32_16x16x32_bf16 v[200:203], a[76:79], v[92:95], v[200:203]
    v_mfma_f32_16x16x32_bf16 v[196:199], a[72:75], v[92:95], v[196:199]
    s_waitcnt vmcnt(10)
    v_mfma_f32_16x16x32_bf16 v[192:195], a[88:91], v[88:91], v[192:195]
    buffer_load_dwordx4 v[92:95], v15, s[28:31], s18 offen offset:0 sc1
    v_mfma_f32_16x16x32_bf16 v[188:191], a[84:87], v[88:91], v[188:191]
    v_mfma_f32_16x16x32_bf16 v[184:187], a[80:83], v[88:91], v[184:187]
    v_mfma_f32_16x16x32_bf16 v[180:183], a[76:79], v[88:91], v[180:183]
    v_mfma_f32_16x16x32_bf16 v[176:179], a[72:75], v[88:91], v[176:179]
    s_waitcnt vmcnt(10)
    v_mfma_f32_16x16x32_bf16 v[172:175], a[88:91], v[84:87], v[172:175]
    buffer_load_dwordx4 v[88:91], v16, s[28:31], s18 offen offset:0 sc1
    v_lshlrev_b32 v28, 16, v26
    v_mfma_f32_16x16x32_bf16 v[168:171], a[84:87], v[84:87], v[168:171]
    v_and_b32 v29, s17, v26
    v_lshlrev_b32 v30, 16, v27
    v_mfma_f32_16x16x32_bf16 v[164:167], a[80:83], v[84:87], v[164:167]
    v_and_b32 v31, s17, v27
    v_lshlrev_b32 v220, 16, v240
    v_mfma_f32_16x16x32_bf16 v[160:163], a[76:79], v[84:87], v[160:163]
    v_and_b32 v221, s17, v240
    v_lshlrev_b32 v222, 16, v241
    v_mfma_f32_16x16x32_bf16 v[156:159], a[72:75], v[84:87], v[156:159]
    v_and_b32 v223, s17, v241
    v_mul_f32 v220, v220, v28
    s_waitcnt vmcnt(10)
    v_mfma_f32_16x16x32_bf16 v[132:135], a[88:91], v[76:79], v[132:135]
    buffer_load_dwordx4 v[84:87], v17, s[28:31], s18 offen offset:0 sc1
    v_mul_f32 v221, v221, v29
    v_mfma_f32_16x16x32_bf16 v[124:127], a[84:87], v[76:79], v[124:127]
    v_mul_f32 v222, v222, v30
    v_mul_f32 v223, v223, v31
    v_mfma_f32_16x16x32_bf16 v[120:123], a[80:83], v[76:79], v[120:123]
    v_lshlrev_b32 v216, 16, v242
    v_and_b32 v217, s17, v242
    v_mfma_f32_16x16x32_bf16 v[116:119], a[76:79], v[76:79], v[116:119]
    v_lshlrev_b32 v218, 16, v243
    v_and_b32 v219, s17, v243
    v_mfma_f32_16x16x32_bf16 v[112:115], a[72:75], v[76:79], v[112:115]
    v_mul_f32 v216, v216, v28
    v_mul_f32 v217, v217, v29
    s_waitcnt vmcnt(10)
    v_mfma_f32_16x16x32_bf16 v[252:255], a[68:71], v[72:75], v[252:255]
    buffer_load_dwordx4 v[76:79], v18, s[28:31], s18 offen offset:0 sc1
    v_mul_f32 v218, v218, v30
    v_mfma_f32_16x16x32_bf16 v[248:251], a[64:67], v[72:75], v[248:251]
    v_mul_f32 v219, v219, v31
    v_lshlrev_b32 v212, 16, v236
    v_mfma_f32_16x16x32_bf16 v[244:247], a[60:63], v[72:75], v[244:247]
    v_and_b32 v213, s17, v236
    v_lshlrev_b32 v214, 16, v237
    v_mfma_f32_16x16x32_bf16 v[200:203], a[56:59], v[72:75], v[200:203]
    v_and_b32 v215, s17, v237
    v_mul_f32 v212, v212, v28
    v_mfma_f32_16x16x32_bf16 v[196:199], a[52:55], v[72:75], v[196:199]
    v_mul_f32 v213, v213, v29
    v_mul_f32 v214, v214, v30
    s_waitcnt vmcnt(10)
    v_mfma_f32_16x16x32_bf16 v[192:195], a[68:71], v[68:71], v[192:195]
    buffer_load_dwordx4 v[72:75], v15, s[28:31], s18 offen offset:1024 sc1
    v_mul_f32 v215, v215, v31
    v_mfma_f32_16x16x32_bf16 v[188:191], a[64:67], v[68:71], v[188:191]
    v_lshlrev_b32 v208, 16, v238
    v_and_b32 v209, s17, v238
    v_mfma_f32_16x16x32_bf16 v[184:187], a[60:63], v[68:71], v[184:187]
    v_lshlrev_b32 v210, 16, v239
    v_and_b32 v211, s17, v239
    v_mfma_f32_16x16x32_bf16 v[180:183], a[56:59], v[68:71], v[180:183]
    v_mul_f32 v208, v208, v28
    v_mul_f32 v209, v209, v29
    v_mfma_f32_16x16x32_bf16 v[176:179], a[52:55], v[68:71], v[176:179]
    v_mul_f32 v210, v210, v30
    v_mul_f32 v211, v211, v31
    s_waitcnt vmcnt(10)
    v_mfma_f32_16x16x32_bf16 v[172:175], a[68:71], v[56:59], v[172:175]
    buffer_load_dwordx4 v[68:71], v16, s[28:31], s18 offen offset:1024 sc1
    v_lshlrev_b32 v204, 16, v232
    v_mfma_f32_16x16x32_bf16 v[168:171], a[64:67], v[56:59], v[168:171]
    v_and_b32 v205, s17, v232
    v_lshlrev_b32 v206, 16, v233
    v_mfma_f32_16x16x32_bf16 v[164:167], a[60:63], v[56:59], v[164:167]
    v_and_b32 v207, s17, v233
    v_mul_f32 v204, v204, v28
    v_mfma_f32_16x16x32_bf16 v[160:163], a[56:59], v[56:59], v[160:163]
    v_mul_f32 v205, v205, v29
    v_mul_f32 v206, v206, v30
    v_mfma_f32_16x16x32_bf16 v[156:159], a[52:55], v[56:59], v[156:159]
    v_mul_f32 v207, v207, v31
    v_add_u32 v8, s48, v10
    s_waitcnt vmcnt(10)
    v_mfma_f32_16x16x32_bf16 v[132:135], a[68:71], v[52:55], v[132:135]
    buffer_load_dwordx4 v[56:59], v17, s[28:31], s18 offen offset:1024 sc1
    v_mfma_f32_16x16x32_bf16 v[124:127], a[64:67], v[52:55], v[124:127]
    ds_read_b128 a[152:155], v8 offset:0
    v_mfma_f32_16x16x32_bf16 v[120:123], a[60:63], v[52:55], v[120:123]
    ds_read_b128 a[148:151], v8 offset:1024
    v_mfma_f32_16x16x32_bf16 v[116:119], a[56:59], v[52:55], v[116:119]
    ds_read_b128 a[144:147], v8 offset:2048
    v_mfma_f32_16x16x32_bf16 v[112:115], a[52:55], v[52:55], v[112:115]
    ds_read_b128 a[140:143], v8 offset:3072
    s_waitcnt vmcnt(10)
    v_mfma_f32_16x16x32_bf16 v[252:255], a[48:51], v[108:111], v[252:255]
    buffer_load_dwordx4 v[52:55], v18, s[28:31], s18 offen offset:1024 sc1
    v_mfma_f32_16x16x32_bf16 v[248:251], a[44:47], v[108:111], v[248:251]
    ds_read_b128 a[136:139], v8 offset:4096
    v_mfma_f32_16x16x32_bf16 v[244:247], a[40:43], v[108:111], v[244:247]
    ds_read_b128 a[132:135], v8 offset:5120
    v_mfma_f32_16x16x32_bf16 v[200:203], a[36:39], v[108:111], v[200:203]
    ds_read_b128 a[128:131], v8 offset:6144
    v_mfma_f32_16x16x32_bf16 v[196:199], a[32:35], v[108:111], v[196:199]
    ds_read_b128 a[124:127], v8 offset:7168
    s_waitcnt vmcnt(10)
    v_mfma_f32_16x16x32_bf16 v[192:195], a[48:51], v[104:107], v[192:195]
    buffer_load_dwordx4 v[108:111], v15, s[28:31], s18 offen offset:2048 sc1
    v_mfma_f32_16x16x32_bf16 v[188:191], a[44:47], v[104:107], v[188:191]
    ds_read_b128 a[120:123], v8 offset:8192
    v_mfma_f32_16x16x32_bf16 v[184:187], a[40:43], v[104:107], v[184:187]
    ds_read_b128 a[116:119], v8 offset:9216
    v_mfma_f32_16x16x32_bf16 v[180:183], a[36:39], v[104:107], v[180:183]
    ds_read_b128 a[112:115], v8 offset:10240
    v_mfma_f32_16x16x32_bf16 v[176:179], a[32:35], v[104:107], v[176:179]
    ds_read_b128 v[152:155], v8 offset:11264
    s_waitcnt vmcnt(10)
    v_mfma_f32_16x16x32_bf16 v[172:175], a[48:51], v[100:103], v[172:175]
    buffer_load_dwordx4 v[104:107], v16, s[28:31], s18 offen offset:2048 sc1
    v_mfma_f32_16x16x32_bf16 v[168:171], a[44:47], v[100:103], v[168:171]
    ds_read_b128 v[148:151], v8 offset:12288
    v_mfma_f32_16x16x32_bf16 v[164:167], a[40:43], v[100:103], v[164:167]
    ds_read_b128 v[144:147], v8 offset:13312
    v_mfma_f32_16x16x32_bf16 v[160:163], a[36:39], v[100:103], v[160:163]
    ds_read_b128 v[140:143], v8 offset:14336
    v_mfma_f32_16x16x32_bf16 v[156:159], a[32:35], v[100:103], v[156:159]
    ds_read_b128 v[136:139], v8 offset:15360
    s_waitcnt vmcnt(10)
    v_mfma_f32_16x16x32_bf16 v[132:135], a[48:51], v[96:99], v[132:135]
    buffer_load_dwordx4 v[100:103], v17, s[28:31], s18 offen offset:2048 sc1
    v_mfma_f32_16x16x32_bf16 v[124:127], a[44:47], v[96:99], v[124:127]
    v_mfma_f32_16x16x32_bf16 v[120:123], a[40:43], v[96:99], v[120:123]
    v_mfma_f32_16x16x32_bf16 v[116:119], a[36:39], v[96:99], v[116:119]
    v_mfma_f32_16x16x32_bf16 v[112:115], a[32:35], v[96:99], v[112:115]
    s_waitcnt vmcnt(10)
    v_mfma_f32_16x16x32_bf16 v[252:255], a[28:31], v[92:95], v[252:255]
    buffer_load_dwordx4 v[96:99], v18, s[28:31], s18 offen offset:2048 sc1
    v_mfma_f32_16x16x32_bf16 v[248:251], a[24:27], v[92:95], v[248:251]
    v_mfma_f32_16x16x32_bf16 v[244:247], a[20:23], v[92:95], v[244:247]
    v_mfma_f32_16x16x32_bf16 v[200:203], a[16:19], v[92:95], v[200:203]
    v_mfma_f32_16x16x32_bf16 v[196:199], a[12:15], v[92:95], v[196:199]
    s_waitcnt vmcnt(10)
    v_mfma_f32_16x16x32_bf16 v[192:195], a[28:31], v[88:91], v[192:195]
    buffer_load_dwordx4 v[92:95], v15, s[28:31], s18 offen offset:3072 sc1
    v_mfma_f32_16x16x32_bf16 v[188:191], a[24:27], v[88:91], v[188:191]
    v_mfma_f32_16x16x32_bf16 v[184:187], a[20:23], v[88:91], v[184:187]
    v_mfma_f32_16x16x32_bf16 v[180:183], a[16:19], v[88:91], v[180:183]
    v_mfma_f32_16x16x32_bf16 v[176:179], a[12:15], v[88:91], v[176:179]
    s_waitcnt vmcnt(10)
    v_mfma_f32_16x16x32_bf16 v[172:175], a[28:31], v[84:87], v[172:175]
    buffer_load_dwordx4 v[88:91], v16, s[28:31], s18 offen offset:3072 sc1
    v_mfma_f32_16x16x32_bf16 v[168:171], a[24:27], v[84:87], v[168:171]
    v_mfma_f32_16x16x32_bf16 v[164:167], a[20:23], v[84:87], v[164:167]
    v_mfma_f32_16x16x32_bf16 v[160:163], a[16:19], v[84:87], v[160:163]
    v_mfma_f32_16x16x32_bf16 v[156:159], a[12:15], v[84:87], v[156:159]
    s_waitcnt vmcnt(10)
    v_mfma_f32_16x16x32_bf16 v[132:135], a[28:31], v[76:79], v[132:135]
    buffer_load_dwordx4 v[84:87], v17, s[28:31], s18 offen offset:3072 sc1
    v_mfma_f32_16x16x32_bf16 v[124:127], a[24:27], v[76:79], v[124:127]
    v_mfma_f32_16x16x32_bf16 v[120:123], a[20:23], v[76:79], v[120:123]
    v_mfma_f32_16x16x32_bf16 v[116:119], a[16:19], v[76:79], v[116:119]
    v_mfma_f32_16x16x32_bf16 v[112:115], a[12:15], v[76:79], v[112:115]
    s_waitcnt vmcnt(10)
    v_mfma_f32_16x16x32_bf16 v[252:255], a[8:11], v[72:75], v[252:255]
    buffer_load_dwordx4 v[76:79], v18, s[28:31], s18 offen offset:3072 sc1
    v_mfma_f32_16x16x32_bf16 v[248:251], a[4:7], v[72:75], v[248:251]
    v_mfma_f32_16x16x32_bf16 v[244:247], a[0:3], v[72:75], v[244:247]
    s_waitcnt lgkmcnt(15)
    v_mfma_f32_16x16x32_bf16 v[200:203], a[152:155], v[72:75], v[200:203]
    s_waitcnt lgkmcnt(14)
    v_mfma_f32_16x16x32_bf16 v[196:199], a[148:151], v[72:75], v[196:199]
    s_waitcnt vmcnt(10)
    v_mfma_f32_16x16x32_bf16 v[192:195], a[8:11], v[68:71], v[192:195]
    buffer_load_dwordx4 v[72:75], v15, s[28:31], s20 offen offset:0 sc1
    v_mfma_f32_16x16x32_bf16 v[188:191], a[4:7], v[68:71], v[188:191]
    v_mfma_f32_16x16x32_bf16 v[184:187], a[0:3], v[68:71], v[184:187]
    v_mfma_f32_16x16x32_bf16 v[180:183], a[152:155], v[68:71], v[180:183]
    v_mfma_f32_16x16x32_bf16 v[176:179], a[148:151], v[68:71], v[176:179]
    s_waitcnt vmcnt(10)
    v_mfma_f32_16x16x32_bf16 v[172:175], a[8:11], v[56:59], v[172:175]
    buffer_load_dwordx4 v[68:71], v16, s[28:31], s20 offen offset:0 sc1
    v_mfma_f32_16x16x32_bf16 v[168:171], a[4:7], v[56:59], v[168:171]
    v_mfma_f32_16x16x32_bf16 v[164:167], a[0:3], v[56:59], v[164:167]
    v_mfma_f32_16x16x32_bf16 v[160:163], a[152:155], v[56:59], v[160:163]
    v_mfma_f32_16x16x32_bf16 v[156:159], a[148:151], v[56:59], v[156:159]
    s_waitcnt vmcnt(10)
    v_mfma_f32_16x16x32_bf16 v[132:135], a[8:11], v[52:55], v[132:135]
    buffer_load_dwordx4 v[56:59], v17, s[28:31], s20 offen offset:0 sc1
    v_mfma_f32_16x16x32_bf16 v[124:127], a[4:7], v[52:55], v[124:127]
    v_mfma_f32_16x16x32_bf16 v[120:123], a[0:3], v[52:55], v[120:123]
    v_mfma_f32_16x16x32_bf16 v[116:119], a[152:155], v[52:55], v[116:119]
    v_mfma_f32_16x16x32_bf16 v[112:115], a[148:151], v[52:55], v[112:115]
    s_waitcnt vmcnt(10) lgkmcnt(13)
    v_mfma_f32_16x16x32_bf16 v[252:255], a[144:147], v[108:111], v[252:255]
    buffer_load_dwordx4 v[52:55], v18, s[28:31], s20 offen offset:0 sc1
    s_waitcnt lgkmcnt(12)
    v_mfma_f32_16x16x32_bf16 v[248:251], a[140:143], v[108:111], v[248:251]
    buffer_load_dword v80, v49, s[28:31], 0 offen offset:384 sc1
    s_waitcnt lgkmcnt(11)
    v_mfma_f32_16x16x32_bf16 v[244:247], a[136:139], v[108:111], v[244:247]
    s_waitcnt lgkmcnt(10)
    v_mfma_f32_16x16x32_bf16 v[200:203], a[132:135], v[108:111], v[200:203]
    s_waitcnt lgkmcnt(9)
    v_mfma_f32_16x16x32_bf16 v[196:199], a[128:131], v[108:111], v[196:199]
    s_waitcnt vmcnt(11)
    v_mfma_f32_16x16x32_bf16 v[192:195], a[144:147], v[104:107], v[192:195]
    v_mfma_f32_16x16x32_bf16 v[188:191], a[140:143], v[104:107], v[188:191]
    v_mfma_f32_16x16x32_bf16 v[184:187], a[136:139], v[104:107], v[184:187]
    v_mfma_f32_16x16x32_bf16 v[180:183], a[132:135], v[104:107], v[180:183]
    v_mfma_f32_16x16x32_bf16 v[176:179], a[128:131], v[104:107], v[176:179]
    s_waitcnt vmcnt(10)
    v_mfma_f32_16x16x32_bf16 v[172:175], a[144:147], v[100:103], v[172:175]
    v_mfma_f32_16x16x32_bf16 v[168:171], a[140:143], v[100:103], v[168:171]
    v_mfma_f32_16x16x32_bf16 v[164:167], a[136:139], v[100:103], v[164:167]
    v_mfma_f32_16x16x32_bf16 v[160:163], a[132:135], v[100:103], v[160:163]
    v_mfma_f32_16x16x32_bf16 v[156:159], a[128:131], v[100:103], v[156:159]
    s_waitcnt vmcnt(9)
    v_mfma_f32_16x16x32_bf16 v[132:135], a[144:147], v[96:99], v[132:135]
    v_mfma_f32_16x16x32_bf16 v[124:127], a[140:143], v[96:99], v[124:127]
    v_mfma_f32_16x16x32_bf16 v[120:123], a[136:139], v[96:99], v[120:123]
    v_mfma_f32_16x16x32_bf16 v[116:119], a[132:135], v[96:99], v[116:119]
    v_mfma_f32_16x16x32_bf16 v[112:115], a[128:131], v[96:99], v[112:115]
    s_waitcnt vmcnt(8) lgkmcnt(8)
    v_mfma_f32_16x16x32_bf16 v[252:255], a[124:127], v[92:95], v[252:255]
    s_waitcnt lgkmcnt(7)
    v_mfma_f32_16x16x32_bf16 v[248:251], a[120:123], v[92:95], v[248:251]
    s_waitcnt lgkmcnt(6)
    v_mfma_f32_16x16x32_bf16 v[244:247], a[116:119], v[92:95], v[244:247]
    s_waitcnt lgkmcnt(5)
    v_mfma_f32_16x16x32_bf16 v[200:203], a[112:115], v[92:95], v[200:203]
    s_waitcnt lgkmcnt(4)
    v_mfma_f32_16x16x32_bf16 v[196:199], v[152:155], v[92:95], v[196:199]
    s_waitcnt vmcnt(7)
    v_mfma_f32_16x16x32_bf16 v[192:195], a[124:127], v[88:91], v[192:195]
    v_mfma_f32_16x16x32_bf16 v[188:191], a[120:123], v[88:91], v[188:191]
    v_mfma_f32_16x16x32_bf16 v[184:187], a[116:119], v[88:91], v[184:187]
    v_mfma_f32_16x16x32_bf16 v[180:183], a[112:115], v[88:91], v[180:183]
    v_mfma_f32_16x16x32_bf16 v[176:179], v[152:155], v[88:91], v[176:179]
    s_waitcnt vmcnt(6)
    v_mfma_f32_16x16x32_bf16 v[172:175], a[124:127], v[84:87], v[172:175]
    v_mfma_f32_16x16x32_bf16 v[168:171], a[120:123], v[84:87], v[168:171]
    v_mfma_f32_16x16x32_bf16 v[164:167], a[116:119], v[84:87], v[164:167]
    v_mfma_f32_16x16x32_bf16 v[160:163], a[112:115], v[84:87], v[160:163]
    v_mfma_f32_16x16x32_bf16 v[156:159], v[152:155], v[84:87], v[156:159]
    s_waitcnt vmcnt(5)
    v_mfma_f32_16x16x32_bf16 v[132:135], a[124:127], v[76:79], v[132:135]
    v_mfma_f32_16x16x32_bf16 v[124:127], a[120:123], v[76:79], v[124:127]
    v_mfma_f32_16x16x32_bf16 v[120:123], a[116:119], v[76:79], v[120:123]
    v_mfma_f32_16x16x32_bf16 v[116:119], a[112:115], v[76:79], v[116:119]
    v_mfma_f32_16x16x32_bf16 v[112:115], v[152:155], v[76:79], v[112:115]
    s_waitcnt vmcnt(4) lgkmcnt(3)
    v_mfma_f32_16x16x32_bf16 v[252:255], v[148:151], v[72:75], v[252:255]
    s_waitcnt vmcnt(0)
    v_cmp_ne_u32 s[50:51], v80, v14
    s_nop 0
    s_cmp_lg_u64 s[50:51], 0
    s_cbranch_scc1 L_spin_fo
L_back_fo:
    s_waitcnt lgkmcnt(2)
    v_mfma_f32_16x16x32_bf16 v[248:251], v[144:147], v[72:75], v[248:251]
    buffer_load_dwordx4 a[108:111], v19, s[28:31], s52 offen offset:0 sc1
    s_waitcnt lgkmcnt(1)
    v_mfma_f32_16x16x32_bf16 v[244:247], v[140:143], v[72:75], v[244:247]
    buffer_load_dwordx4 a[104:107], v19, s[28:31], s52 offen offset:1024 sc1
    s_waitcnt lgkmcnt(0)
    v_mfma_f32_16x16x32_bf16 v[200:203], v[136:139], v[72:75], v[200:203]
    buffer_load_dwordx4 a[100:103], v19, s[28:31], s52 offen offset:2048 sc1
    v_mfma_f32_16x16x32_bf16 v[196:199], v[128:131], v[72:75], v[196:199]
    buffer_load_dwordx4 a[96:99], v19, s[28:31], s52 offen offset:3072 sc1
    v_mfma_f32_16x16x32_bf16 v[192:195], v[148:151], v[68:71], v[192:195]
    buffer_load_dwordx2 a[92:93], v43, s[28:31], s53 offen offset:0 sc1
    v_mfma_f32_16x16x32_bf16 v[188:191], v[144:147], v[68:71], v[188:191]
    buffer_load_dwordx2 a[94:95], v43, s[28:31], s53 offen offset:128 sc1
    v_mfma_f32_16x16x32_bf16 v[184:187], v[140:143], v[68:71], v[184:187]
    buffer_load_dwordx4 a[88:91], v34, s[28:31], s52 offen offset:0 sc1
    v_mfma_f32_16x16x32_bf16 v[180:183], v[136:139], v[68:71], v[180:183]
    buffer_load_dwordx4 a[84:87], v34, s[28:31], s52 offen offset:1024 sc1
    v_mfma_f32_16x16x32_bf16 v[176:179], v[128:131], v[68:71], v[176:179]
    buffer_load_dwordx4 a[80:83], v34, s[28:31], s52 offen offset:2048 sc1
    v_mfma_f32_16x16x32_bf16 v[172:175], v[148:151], v[56:59], v[172:175]
    buffer_load_dwordx4 a[76:79], v34, s[28:31], s52 offen offset:3072 sc1
    v_mfma_f32_16x16x32_bf16 v[168:171], v[144:147], v[56:59], v[168:171]
    buffer_load_dwordx2 a[72:73], v43, s[28:31], s59 offen offset:0 sc1
    v_mfma_f32_16x16x32_bf16 v[164:167], v[140:143], v[56:59], v[164:167]
    buffer_load_dwordx2 a[74:75], v43, s[28:31], s59 offen offset:128 sc1
    v_mfma_f32_16x16x32_bf16 v[160:163], v[136:139], v[56:59], v[160:163]
    buffer_load_dwordx4 a[68:71], v35, s[28:31], s52 offen offset:0 sc1
    v_mfma_f32_16x16x32_bf16 v[156:159], v[128:131], v[56:59], v[156:159]
    buffer_load_dwordx4 a[64:67], v35, s[28:31], s52 offen offset:1024 sc1
    v_mfma_f32_16x16x32_bf16 v[132:135], v[148:151], v[52:55], v[132:135]
    buffer_load_dwordx4 a[60:63], v35, s[28:31], s52 offen offset:2048 sc1
    v_mfma_f32_16x16x32_bf16 v[124:127], v[144:147], v[52:55], v[124:127]
    buffer_load_dwordx4 a[56:59], v35, s[28:31], s52 offen offset:3072 sc1
    v_mfma_f32_16x16x32_bf16 v[120:123], v[140:143], v[52:55], v[120:123]
    buffer_load_dwordx4 a[52:55], v40, s[28:31], s52 offen offset:0 sc1
    v_mfma_f32_16x16x32_bf16 v[116:119], v[136:139], v[52:55], v[116:119]
    buffer_load_dwordx4 a[48:51], v40, s[28:31], s52 offen offset:1024 sc1
    v_mfma_f32_16x16x32_bf16 v[112:115], v[128:131], v[52:55], v[112:115]
    buffer_load_dwordx4 a[44:47], v40, s[28:31], s52 offen offset:2048 sc1
    buffer_load_dwordx4 a[40:43], v40, s[28:31], s52 offen offset:3072 sc1
    s_barrier
    v_pk_mul_f32 v[252:253], v[252:253], v[36:37] op_sel:[0,0] op_sel_hi:[1,0]
    v_pk_mul_f32 v[254:255], v[254:255], v[36:37] op_sel:[0,0] op_sel_hi:[1,0]
    v_pk_mul_f32 v[248:249], v[248:249], v[36:37] op_sel:[0,0] op_sel_hi:[1,0]
    v_pk_mul_f32 v[250:251], v[250:251], v[36:37] op_sel:[0,0] op_sel_hi:[1,0]
    v_pk_mul_f32 v[244:245], v[244:245], v[36:37] op_sel:[0,0] op_sel_hi:[1,0]
    v_pk_mul_f32 v[246:247], v[246:247], v[36:37] op_sel:[0,0] op_sel_hi:[1,0]
    v_pk_mul_f32 v[200:201], v[200:201], v[36:37] op_sel:[0,0] op_sel_hi:[1,0]
    v_pk_mul_f32 v[202:203], v[202:203], v[36:37] op_sel:[0,0] op_sel_hi:[1,0]
    v_pk_mul_f32 v[196:197], v[196:197], v[36:37] op_sel:[0,0] op_sel_hi:[1,0]
    v_pk_mul_f32 v[198:199], v[198:199], v[36:37] op_sel:[0,0] op_sel_hi:[1,0]
    v_pk_mul_f32 v[192:193], v[192:193], v[36:37] op_sel:[0,1] op_sel_hi:[1,1]
    v_pk_mul_f32 v[194:195], v[194:195], v[36:37] op_sel:[0,1] op_sel_hi:[1,1]
    v_pk_mul_f32 v[188:189], v[188:189], v[36:37] op_sel:[0,1] op_sel_hi:[1,1]
    v_pk_mul_f32 v[190:191], v[190:191], v[36:37] op_sel:[0,1] op_sel_hi:[1,1]
    v_pk_mul_f32 v[184:185], v[184:185], v[36:37] op_sel:[0,1] op_sel_hi:[1,1]
    v_pk_mul_f32 v[186:187], v[186:187], v[36:37] op_sel:[0,1] op_sel_hi:[1,1]
    v_pk_mul_f32 v[180:181], v[180:181], v[36:37] op_sel:[0,1] op_sel_hi:[1,1]
    v_pk_mul_f32 v[182:183], v[182:183], v[36:37] op_sel:[0,1] op_sel_hi:[1,1]
    v_pk_mul_f32 v[176:177], v[176:177], v[36:37] op_sel:[0,1] op_sel_hi:[1,1]
    v_pk_mul_f32 v[178:179], v[178:179], v[36:37] op_sel:[0,1] op_sel_hi:[1,1]
    v_pk_mul_f32 v[172:173], v[172:173], v[38:39] op_sel:[0,0] op_sel_hi:[1,0]
    v_pk_mul_f32 v[174:175], v[174:175], v[38:39] op_sel:[0,0] op_sel_hi:[1,0]
    v_pk_mul_f32 v[168:169], v[168:169], v[38:39] op_sel:[0,0] op_sel_hi:[1,0]
    v_pk_mul_f32 v[170:171], v[170:171], v[38:39] op_sel:[0,0] op_sel_hi:[1,0]
    v_pk_mul_f32 v[164:165], v[164:165], v[38:39] op_sel:[0,0] op_sel_hi:[1,0]
    v_pk_mul_f32 v[166:167], v[166:167], v[38:39] op_sel:[0,0] op_sel_hi:[1,0]
    v_pk_mul_f32 v[160:161], v[160:161], v[38:39] op_sel:[0,0] op_sel_hi:[1,0]
    v_pk_mul_f32 v[162:163], v[162:163], v[38:39] op_sel:[0,0] op_sel_hi:[1,0]
    v_pk_mul_f32 v[156:157], v[156:157], v[38:39] op_sel:[0,0] op_sel_hi:[1,0]
    v_pk_mul_f32 v[158:159], v[158:159], v[38:39] op_sel:[0,0] op_sel_hi:[1,0]
    v_pk_mul_f32 v[132:133], v[132:133], v[38:39] op_sel:[0,1] op_sel_hi:[1,1]
    v_pk_mul_f32 v[134:135], v[134:135], v[38:39] op_sel:[0,1] op_sel_hi:[1,1]
    v_pk_mul_f32 v[124:125], v[124:125], v[38:39] op_sel:[0,1] op_sel_hi:[1,1]
    v_pk_mul_f32 v[126:127], v[126:127], v[38:39] op_sel:[0,1] op_sel_hi:[1,1]
    v_pk_mul_f32 v[120:121], v[120:121], v[38:39] op_sel:[0,1] op_sel_hi:[1,1]
    v_pk_mul_f32 v[122:123], v[122:123], v[38:39] op_sel:[0,1] op_sel_hi:[1,1]
    v_pk_mul_f32 v[116:117], v[116:117], v[38:39] op_sel:[0,1] op_sel_hi:[1,1]
    v_pk_mul_f32 v[118:119], v[118:119], v[38:39] op_sel:[0,1] op_sel_hi:[1,1]
    v_pk_mul_f32 v[112:113], v[112:113], v[38:39] op_sel:[0,1] op_sel_hi:[1,1]
    v_pk_mul_f32 v[114:115], v[114:115], v[38:39] op_sel:[0,1] op_sel_hi:[1,1]
    s_waitcnt vmcnt(19)
    v_mfma_f32_16x16x32_bf16 v[252:255], a[252:255], a[108:111], v[252:255]
    v_mfma_f32_16x16x32_bf16 v[248:251], a[248:251], a[108:111], v[248:251]
    v_mfma_f32_16x16x32_bf16 v[244:247], a[244:247], a[108:111], v[244:247]
    v_mfma_f32_16x16x32_bf16 v[200:203], a[240:243], a[108:111], v[200:203]
    v_mfma_f32_16x16x32_bf16 v[196:199], a[236:239], a[108:111], v[196:199]
    s_waitcnt vmcnt(18)
    v_mfma_f32_16x16x32_bf16 v[252:255], a[232:235], a[104:107], v[252:255]
    v_mfma_f32_16x16x32_bf16 v[248:251], a[228:231], a[104:107], v[248:251]
    v_mfma_f32_16x16x32_bf16 v[244:247], a[224:227], a[104:107], v[244:247]
    v_mfma_f32_16x16x32_bf16 v[200:203], a[220:223], a[104:107], v[200:203]
    v_mfma_f32_16x16x32_bf16 v[196:199], a[216:219], a[104:107], v[196:199]
    s_waitcnt vmcnt(17)
    v_mfma_f32_16x16x32_bf16 v[252:255], a[212:215], a[100:103], v[252:255]
    v_mfma_f32_16x16x32_bf16 v[248:251], a[208:211], a[100:103], v[248:251]
    v_mfma_f32_16x16x32_bf16 v[244:247], a[204:207], a[100:103], v[244:247]
    v_mfma_f32_16x16x32_bf16 v[200:203], a[200:203], a[100:103], v[200:203]
    v_mfma_f32_16x16x32_bf16 v[196:199], a[196:199], a[100:103], v[196:199]
    s_waitcnt vmcnt(16)
    v_mfma_f32_16x16x32_bf16 v[252:255], a[192:195], a[96:99], v[252:255]
    v_mfma_f32_16x16x32_bf16 v[248:251], a[188:191], a[96:99], v[248:251]
    v_mfma_f32_16x16x32_bf16 v[244:247], a[184:187], a[96:99], v[244:247]
    v_mfma_f32_16x16x32_bf16 v[200:203], a[180:183], a[96:99], v[200:203]
    v_mfma_f32_16x16x32_bf16 v[196:199], a[176:179], a[96:99], v[196:199]
    s_waitcnt vmcnt(14)
    v_mfma_f32_16x16x32_bf16 v[252:255], a[172:175], a[92:95], v[252:255]
    v_mfma_f32_16x16x32_bf16 v[248:251], a[168:171], a[92:95], v[248:251]
    v_mfma_f32_16x16x32_bf16 v[244:247], a[164:167], a[92:95], v[244:247]
    v_mfma_f32_16x16x32_bf16 v[200:203], a[160:163], a[92:95], v[200:203]
    v_mfma_f32_16x16x32_bf16 v[196:199], a[156:159], a[92:95], v[196:199]
    s_waitcnt vmcnt(13)
    v_mfma_f32_16x16x32_bf16 v[192:195], a[252:255], a[88:91], v[192:195]
    v_mfma_f32_16x16x32_bf16 v[188:191], a[248:251], a[88:91], v[188:191]
    v_mfma_f32_16x16x32_bf16 v[184:187], a[244:247], a[88:91], v[184:187]
    v_mfma_f32_16x16x32_bf16 v[180:183], a[240:243], a[88:91], v[180:183]
    v_mfma_f32_16x16x32_bf16 v[176:179], a[236:239], a[88:91], v[176:179]
    s_waitcnt vmcnt(12)
    v_mfma_f32_16x16x32_bf16 v[192:195], a[232:235], a[84:87], v[192:195]
    ds_write_b128 v41, v[252:255] offset:0
    v_mfma_f32_16x16x32_bf16 v[188:191], a[228:231], a[84:87], v[188:191]
    ds_write_b128 v41, v[248:251] offset:64
    v_mfma_f32_16x16x32_bf16 v[184:187], a[224:227], a[84:87], v[184:187]
    ds_write_b128 v41, v[244:247] offset:128
    v_mfma_f32_16x16x32_bf16 v[180:183], a[220:223], a[84:87], v[180:183]
    ds_write_b128 v41, v[200:203] offset:192
    v_mfma_f32_16x16x32_bf16 v[176:179], a[216:219], a[84:87], v[176:179]
    ds_write_b128 v41, v[196:199] offset:256
    s_waitcnt vmcnt(11)
    v_mfma_f32_16x16x32_bf16 v[192:195], a[212:215], a[80:83], v[192:195]
    v_mfma_f32_16x16x32_bf16 v[188:191], a[208:211], a[80:83], v[188:191]
    v_mfma_f32_16x16x32_bf16 v[184:187], a[204:207], a[80:83], v[184:187]
    v_mfma_f32_16x16x32_bf16 v[180:183], a[200:203], a[80:83], v[180:183]
    v_mfma_f32_16x16x32_bf16 v[176:179], a[196:199], a[80:83], v[176:179]
    s_waitcnt vmcnt(10)
    v_mfma_f32_16x16x32_bf16 v[192:195], a[192:195], a[76:79], v[192:195]
    v_mfma_f32_16x16x32_bf16 v[188:191], a[188:191], a[76:79], v[188:191]
    v_mfma_f32_16x16x32_bf16 v[184:187], a[184:187], a[76:79], v[184:187]
    v_mfma_f32_16x16x32_bf16 v[180:183], a[180:183], a[76:79], v[180:183]
    v_mfma_f32_16x16x32_bf16 v[176:179], a[176:179], a[76:79], v[176:179]
    s_waitcnt vmcnt(8)
    v_mfma_f32_16x16x32_bf16 v[192:195], a[172:175], a[72:75], v[192:195]
    v_mfma_f32_16x16x32_bf16 v[188:191], a[168:171], a[72:75], v[188:191]
    v_mfma_f32_16x16x32_bf16 v[184:187], a[164:167], a[72:75], v[184:187]
    v_mfma_f32_16x16x32_bf16 v[180:183], a[160:163], a[72:75], v[180:183]
    v_mfma_f32_16x16x32_bf16 v[176:179], a[156:159], a[72:75], v[176:179]
    s_waitcnt vmcnt(7)
    v_mfma_f32_16x16x32_bf16 v[172:175], a[252:255], a[68:71], v[172:175]
    v_mfma_f32_16x16x32_bf16 v[168:171], a[248:251], a[68:71], v[168:171]
    v_mfma_f32_16x16x32_bf16 v[164:167], a[244:247], a[68:71], v[164:167]
    v_mfma_f32_16x16x32_bf16 v[160:163], a[240:243], a[68:71], v[160:163]
    v_mfma_f32_16x16x32_bf16 v[156:159], a[236:239], a[68:71], v[156:159]
    s_waitcnt vmcnt(6)
    v_mfma_f32_16x16x32_bf16 v[172:175], a[232:235], a[64:67], v[172:175]
    ds_write_b128 v41, v[192:195] offset:1344
    v_mfma_f32_16x16x32_bf16 v[168:171], a[228:231], a[64:67], v[168:171]
    ds_write_b128 v41, v[188:191] offset:1408
    v_mfma_f32_16x16x32_bf16 v[164:167], a[224:227], a[64:67], v[164:167]
    ds_write_b128 v41, v[184:187] offset:1472
    v_mfma_f32_16x16x32_bf16 v[160:163], a[220:223], a[64:67], v[160:163]
    ds_write_b128 v41, v[180:183] offset:1536
    v_mfma_f32_16x16x32_bf16 v[156:159], a[216:219], a[64:67], v[156:159]
    ds_write_b128 v41, v[176:179] offset:1600
    s_waitcnt vmcnt(5)
    v_mfma_f32_16x16x32_bf16 v[172:175], a[212:215], a[60:63], v[172:175]
    v_mfma_f32_16x16x32_bf16 v[168:171], a[208:211], a[60:63], v[168:171]
    v_mfma_f32_16x16x32_bf16 v[164:167], a[204:207], a[60:63], v[164:167]
    v_mfma_f32_16x16x32_bf16 v[160:163], a[200:203], a[60:63], v[160:163]
    v_mfma_f32_16x16x32_bf16 v[156:159], a[196:199], a[60:63], v[156:159]
    s_waitcnt vmcnt(4)
    v_mfma_f32_16x16x32_bf16 v[172:175], a[192:195], a[56:59], v[172:175]
    v_mfma_f32_16x16x32_bf16 v[168:171], a[188:191], a[56:59], v[168:171]
    v_mfma_f32_16x16x32_bf16 v[164:167], a[184:187], a[56:59], v[164:167]
    v_mfma_f32_16x16x32_bf16 v[160:163], a[180:183], a[56:59], v[160:163]
    v_mfma_f32_16x16x32_bf16 v[156:159], a[176:179], a[56:59], v[156:159]
    s_waitcnt vmcnt(3)
    v_mfma_f32_16x16x32_bf16 v[132:135], a[252:255], a[52:55], v[132:135]
    v_mfma_f32_16x16x32_bf16 v[124:127], a[248:251], a[52:55], v[124:127]
    v_mfma_f32_16x16x32_bf16 v[120:123], a[244:247], a[52:55], v[120:123]
    v_mfma_f32_16x16x32_bf16 v[116:119], a[240:243], a[52:55], v[116:119]
    v_mfma_f32_16x16x32_bf16 v[112:115], a[236:239], a[52:55], v[112:115]
    s_waitcnt vmcnt(2)
    v_mfma_f32_16x16x32_bf16 v[132:135], a[232:235], a[48:51], v[132:135]
    ds_write_b128 v42, v[172:175] offset:0
    v_mfma_f32_16x16x32_bf16 v[124:127], a[228:231], a[48:51], v[124:127]
    ds_write_b128 v42, v[168:171] offset:64
    v_mfma_f32_16x16x32_bf16 v[120:123], a[224:227], a[48:51], v[120:123]
    ds_write_b128 v42, v[164:167] offset:128
    v_mfma_f32_16x16x32_bf16 v[116:119], a[220:223], a[48:51], v[116:119]
    ds_write_b128 v42, v[160:163] offset:192
    v_mfma_f32_16x16x32_bf16 v[112:115], a[216:219], a[48:51], v[112:115]
    ds_write_b128 v42, v[156:159] offset:256
    s_waitcnt vmcnt(1)
    v_mfma_f32_16x16x32_bf16 v[132:135], a[212:215], a[44:47], v[132:135]
    v_mfma_f32_16x16x32_bf16 v[124:127], a[208:211], a[44:47], v[124:127]
    v_mfma_f32_16x16x32_bf16 v[120:123], a[204:207], a[44:47], v[120:123]
    v_mfma_f32_16x16x32_bf16 v[116:119], a[200:203], a[44:47], v[116:119]
    v_mfma_f32_16x16x32_bf16 v[112:115], a[196:199], a[44:47], v[112:115]
    s_waitcnt vmcnt(0)
    v_mfma_f32_16x16x32_bf16 v[132:135], a[192:195], a[40:43], v[132:135]
    v_mfma_f32_16x16x32_bf16 v[124:127], a[188:191], a[40:43], v[124:127]
    v_mfma_f32_16x16x32_bf16 v[120:123], a[184:187], a[40:43], v[120:123]
    v_mfma_f32_16x16x32_bf16 v[116:119], a[180:183], a[40:43], v[116:119]
    v_mfma_f32_16x16x32_bf16 v[112:115], a[176:179], a[40:43], v[112:115]
    s_nop 3
    ds_write_b128 v42, v[132:135] offset:1344
    ds_write_b128 v42, v[124:127] offset:1408
    ds_write_b128 v42, v[120:123] offset:1472
    ds_write_b128 v42, v[116:119] offset:1536
    ds_write_b128 v42, v[112:115] offset:1600
    s_waitcnt lgkmcnt(0)
    s_barrier
    ds_read_b128 v[252:255], v20 offset:0
    ds_read_b128 v[248:251], v20 offset:21504
    ds_read_b128 v[244:247], v21 offset:0
    ds_read_b128 v[200:203], v21 offset:21504
    ds_read_b128 v[196:199], v20 offset:4704
    ds_read_b128 v[192:195], v20 offset:26208
    ds_read_b128 v[188:191], v21 offset:4704
    ds_read_b128 v[184:187], v21 offset:26208
    ds_read_b128 v[180:183], v20 offset:9408
    ds_read_b128 v[176:179], v20 offset:30912
    ds_read_b128 v[172:175], v21 offset:9408
    ds_read_b128 v[168:171], v21 offset:30912
    ds_read_b128 v[164:167], v20 offset:14112
    ds_read_b128 v[160:163], v20 offset:35616
    ds_read_b128 v[156:159], v21 offset:14112
    ds_read_b128 v[132:135], v21 offset:35616
    ds_read_b128 v[124:127], v20 offset:18816
    ds_read_b128 v[120:123], v20 offset:40320
    ds_read_b128 v[116:119], v21 offset:18816
    ds_read_b128 v[112:115], v21 offset:40320
    s_waitcnt lgkmcnt(15)
    v_pk_fma_f32 v[252:253], v[220:221], v[228:229], v[252:253] op_sel:[0,0,0] op_sel_hi:[1,0,1]
    v_pk_add_f32 v[252:253], v[252:253], v[248:249]
    v_pk_add_f32 v[244:245], v[244:245], v[200:201]
    v_pk_add_f32 v[252:253], v[252:253], v[244:245]
    v_pk_fma_f32 v[254:255], v[222:223], v[228:229], v[254:255] op_sel:[0,0,0] op_sel_hi:[1,0,1]
    v_pk_add_f32 v[254:255], v[254:255], v[250:251]
    v_pk_add_f32 v[246:247], v[246:247], v[202:203]
    v_pk_add_f32 v[254:255], v[254:255], v[246:247]
    buffer_store_dwordx4 v[252:255], v22, s[44:47], s73 offen
    v_pk_fma_f32 v[196:197], v[216:217], v[228:229], v[196:197] op_sel:[0,1,0] op_sel_hi:[1,1,1]
    s_waitcnt lgkmcnt(14)
    v_pk_add_f32 v[196:197], v[196:197], v[192:193]
    s_waitcnt lgkmcnt(12)
    v_pk_add_f32 v[188:189], v[188:189], v[184:185]
    v_pk_add_f32 v[196:197], v[196:197], v[188:189]
    v_pk_fma_f32 v[198:199], v[218:219], v[228:229], v[198:199] op_sel:[0,1,0] op_sel_hi:[1,1,1]
    v_pk_add_f32 v[198:199], v[198:199], v[194:195]
    v_pk_add_f32 v[190:191], v[190:191], v[186:187]
    v_pk_add_f32 v[198:199], v[198:199], v[190:191]
    buffer_store_dwordx4 v[196:199], v22, s[44:47], s74 offen
    s_waitcnt lgkmcnt(11)
    v_pk_fma_f32 v[180:181], v[212:213], v[230:231], v[180:181] op_sel:[0,0,0] op_sel_hi:[1,0,1]
    s_waitcnt lgkmcnt(10)
    v_pk_add_f32 v[180:181], v[180:181], v[176:177]
    s_waitcnt lgkmcnt(8)
    v_pk_add_f32 v[172:173], v[172:173], v[168:169]
    v_pk_add_f32 v[180:181], v[180:181], v[172:173]
    v_pk_fma_f32 v[182:183], v[214:215], v[230:231], v[182:183] op_sel:[0,0,0] op_sel_hi:[1,0,1]
    v_pk_add_f32 v[182:183], v[182:183], v[178:179]
    v_pk_add_f32 v[174:175], v[174:175], v[170:171]
    v_pk_add_f32 v[182:183], v[182:183], v[174:175]
    buffer_store_dwordx4 v[180:183], v22, s[44:47], s75 offen
    s_waitcnt lgkmcnt(7)
    v_pk_fma_f32 v[164:165], v[208:209], v[230:231], v[164:165] op_sel:[0,1,0] op_sel_hi:[1,1,1]
    s_waitcnt lgkmcnt(6)
    v_pk_add_f32 v[164:165], v[164:165], v[160:161]
    s_waitcnt lgkmcnt(4)
    v_pk_add_f32 v[156:157], v[156:157], v[132:133]
    v_pk_add_f32 v[164:165], v[164:165], v[156:157]
    v_pk_fma_f32 v[166:167], v[210:211], v[230:231], v[166:167] op_sel:[0,1,0] op_sel_hi:[1,1,1]
    v_pk_add_f32 v[166:167], v[166:167], v[162:163]
    v_pk_add_f32 v[158:159], v[158:159], v[134:135]
    v_pk_add_f32 v[166:167], v[166:167], v[158:159]
    buffer_store_dwordx4 v[164:167], v22, s[44:47], s76 offen
    s_waitcnt lgkmcnt(3)
    v_pk_fma_f32 v[124:125], v[204:205], v[224:225], v[124:125] op_sel:[0,0,0] op_sel_hi:[1,0,1]
    s_waitcnt lgkmcnt(2)
    v_pk_add_f32 v[124:125], v[124:125], v[120:121]
    s_waitcnt lgkmcnt(0)
    v_pk_add_f32 v[116:117], v[116:117], v[112:113]
    v_pk_add_f32 v[124:125], v[124:125], v[116:117]
    v_pk_fma_f32 v[126:127], v[206:207], v[224:225], v[126:127] op_sel:[0,0,0] op_sel_hi:[1,0,1]
    v_pk_add_f32 v[126:127], v[126:127], v[122:123]
    v_pk_add_f32 v[118:119], v[118:119], v[114:115]
    v_pk_add_f32 v[126:127], v[126:127], v[118:119]
    buffer_store_dwordx4 v[124:127], v23, s[44:47], s77 offen
    v_cmp_eq_u32 vcc, 4096, v66
    s_nop 1
    v_cndmask_b32_e64 v1, v11, 0, vcc
    buffer_store_dword v14, v1, s[28:31], 0 offen sc1
L_end:
    s_endpgm
L_spin_f0:
    s_mov_b32 s49, 0
L_loop_f0:
    buffer_load_dword v80, v151, s[28:31], 0 offen offset:0 sc1
    s_add_u32 s49, s49, 1
    s_waitcnt vmcnt(0)
    v_cmp_ne_u32 s[50:51], v80, v14
    s_cmp_gt_u32 s49, 200000
    s_cbranch_scc1 L_back_f0
    s_cmp_lg_u64 s[50:51], 0
    s_cbranch_scc1 L_loop_f0
    s_branch L_back_f0
L_spin_fc:
    s_mov_b32 s49, 0
L_loop_fc:
    buffer_load_dword v80, v119, s[28:31], 0 offen offset:128 sc1
    s_add_u32 s49, s49, 1
    s_waitcnt vmcnt(0)
    v_cmp_ne_u32 s[50:51], v80, v14
    s_cmp_gt_u32 s49, 200000
    s_cbranch_scc1 L_back_fc
    s_cmp_lg_u64 s[50:51], 0
    s_cbranch_scc1 L_loop_fc
    s_branch L_back_fc
L_spin_ag:
    s_mov_b32 s49, 0
L_loop_ag:
    buffer_load_dwordx4 v[212:215], v50, s[28:31], s23 offen sc1
    buffer_load_dwordx4 v[208:211], v50, s[28:31], s24 offen sc1
    buffer_load_dwordx4 v[204:207], v50, s[28:31], s25 offen sc1
    buffer_load_dwordx4 v[200:203], v50, s[28:31], s26 offen sc1
    s_waitcnt vmcnt(0)
    s_add_u32 s49, s49, 1
    v_xor_b32 v1, v214, v14
    v_bitop3_b32 v1, v1, v210, v14 bitop3:0xf6
    v_bitop3_b32 v1, v1, v206, v14 bitop3:0xf6
    v_bitop3_b32 v1, v1, v202, v14 bitop3:0xf6
    v_cmp_ne_u32 vcc, 0, v1
    s_cmp_gt_u32 s49, 200000
    s_cbranch_scc1 L_back_ag
    s_and_b32 vcc_hi, vcc_hi, 0xff
    s_cmp_lg_u64 vcc, 0
    s_cbranch_scc1 L_loop_ag
    s_branch L_back_ag
L_spin_kv:
    s_mov_b32 s49, 0
L_loop_kv:
    buffer_load_dwordx4 v[252:255], v68, s[28:31], 0 offen offset:0 sc1
    buffer_load_dwordx4 v[248:251], v68, s[28:31], 0 offen offset:1024 sc1
    buffer_load_dwordx4 v[244:247], v68, s[28:31], 0 offen offset:2048 sc1
    buffer_load_dwordx4 v[240:243], v68, s[28:31], 0 offen offset:3072 sc1
    buffer_load_dwordx4 v[236:239], v68, s[28:31], s18 offen offset:0 sc1
    buffer_load_dwordx4 v[232:235], v68, s[28:31], s18 offen offset:1024 sc1
    buffer_load_dwordx4 v[228:231], v68, s[28:31], s18 offen offset:2048 sc1
    buffer_load_dwordx4 v[224:227], v68, s[28:31], s18 offen offset:3072 sc1
    buffer_load_dwordx4 v[220:223], v68, s[28:31], s20 offen offset:0 sc1
    buffer_load_dwordx4 v[216:219], v68, s[28:31], s20 offen offset:1024 sc1
    buffer_load_dwordx4 v[212:215], v68, s[28:31], s20 offen offset:2048 sc1
    buffer_load_dwordx4 v[208:211], v68, s[28:31], s20 offen offset:3072 sc1
    buffer_load_dwordx4 v[204:207], v68, s[28:31], s21 offen offset:0 sc1
    buffer_load_dwordx4 v[200:203], v68, s[28:31], s21 offen offset:1024 sc1
    buffer_load_dwordx4 v[180:183], v68, s[28:31], s21 offen offset:2048 sc1
    buffer_load_dwordx4 v[176:179], v68, s[28:31], s21 offen offset:3072 sc1
    s_waitcnt vmcnt(0)
    s_add_u32 s49, s49, 1
    v_xor_b32 v1, v255, v14
    v_bitop3_b32 v1, v1, v251, v14 bitop3:0xf6
    v_bitop3_b32 v1, v1, v247, v14 bitop3:0xf6
    v_bitop3_b32 v1, v1, v243, v14 bitop3:0xf6
    v_bitop3_b32 v1, v1, v239, v14 bitop3:0xf6
    v_bitop3_b32 v1, v1, v235, v14 bitop3:0xf6
    v_bitop3_b32 v1, v1, v231, v14 bitop3:0xf6
    v_bitop3_b32 v1, v1, v227, v14 bitop3:0xf6
    v_bitop3_b32 v1, v1, v223, v14 bitop3:0xf6
    v_bitop3_b32 v1, v1, v219, v14 bitop3:0xf6
    v_bitop3_b32 v1, v1, v215, v14 bitop3:0xf6
    v_bitop3_b32 v1, v1, v211, v14 bitop3:0xf6
    v_bitop3_b32 v1, v1, v207, v14 bitop3:0xf6
    v_bitop3_b32 v1, v1, v203, v14 bitop3:0xf6
    v_bitop3_b32 v1, v1, v183, v14 bitop3:0xf6
    v_bitop3_b32 v1, v1, v179, v14 bitop3:0xf6
    v_cmp_ne_u32 vcc, 0, v1
    s_cmp_gt_u32 s49, 200000
    s_cbranch_scc1 L_back_kv
    s_cbranch_vccnz L_loop_kv
    s_branch L_redo_kv
L_spin_fh:
    s_mov_b32 s49, 0
L_loop_fh:
    buffer_load_dword v80, v49, s[28:31], 0 offen offset:256 sc1
    s_add_u32 s49, s49, 1
    s_waitcnt vmcnt(0)
    v_cmp_ne_u32 s[50:51], v80, v14
    s_cmp_gt_u32 s49, 200000
    s_cbranch_scc1 L_back_fh
    s_cmp_lg_u64 s[50:51], 0
    s_cbranch_scc1 L_loop_fh
    s_branch L_back_fh
L_spin_fo:
    s_mov_b32 s49, 0
L_loop_fo:
    buffer_load_dword v80, v49, s[28:31], 0 offen offset:384 sc1
    s_add_u32 s49, s49, 1
    s_waitcnt vmcnt(0)
    v_cmp_ne_u32 s[50:51], v80, v14
    s_cmp_gt_u32 s49, 200000
    s_cbranch_scc1 L_back_fo
    s_cmp_lg_u64 s[50:51], 0
    s_cbranch_scc1 L_loop_fo
    s_branch L_back_fo
    s_endpgm
.fill 8192, 4, 0xbf810000
.section .rodata,"a"
.p2align 6
.amdhsa_kernel gated_mix__ssm_conv_s5__linear_kernel_hedgehog__prompt_kernel
  .amdhsa_next_free_vgpr 512
  .amdhsa_next_free_sgpr 102
  .amdhsa_accum_offset 256
  .amdhsa_group_segment_fixed_size 0
  .amdhsa_kernarg_size 136
  .amdhsa_user_sgpr_count 2
  .amdhsa_user_sgpr_kernarg_segment_ptr 1
  .amdhsa_system_sgpr_workgroup_id_x 1
  .amdhsa_float_denorm_mode_32 3
.end_amdhsa_kernel
```
